```python
import torch

def _softmax(x, axis=-1):
    return torch.softmax(x, dim=axis)
def _gelu(x):
    return torch.nn.functional.gelu(x, approximate="tanh")
def _silu(x):
    return torch.nn.functional.silu(x)
def _sigmoid(x):
    return torch.sigmoid(x)
def _layernorm(x, axis=-1, eps=1e-5):
    m = x.mean(dim=axis, keepdim=True)
    v = x.var(dim=axis, keepdim=True, unbiased=False)
    return (x - m) / torch.sqrt(v + eps)
def _scatter_add(tgt, idx, src, axis=0):
    return tgt.clone().index_add_(axis, idx, src)
def _segment_sum(src, seg, n):
    out = torch.zeros((n,) + src.shape[1:], dtype=src.dtype)
    return out.index_add_(0, seg, src)
def _pad(x, pw):
    flat = tuple(v for pair in reversed(pw) for v in pair)
    return torch.nn.functional.pad(x, flat)

kernel_name = 'gated_mix__grouped_kv_mqa__glu_gated_swiglu__prompt'

def setup_inputs():

    _w = (lambda a: (lambda t: t.to(torch.bfloat16) if t.is_floating_point() else t)(torch.as_tensor(a)))
    def _A_setup():
        B, S, D, H = 1, 2048, 512, 32
        Dh = D // H
        return {
            "x": _w((lambda *s: torch.randn(*s, dtype=torch.bfloat16) * 0.05)(B, S, D)),
            "wq": _w((lambda *s: torch.randn(*s, dtype=torch.bfloat16) * 0.8)(D, H * Dh)),
            "wk": _w((lambda *s: torch.randn(*s, dtype=torch.bfloat16) * 0.8)(D, Dh)),
            "wv": _w((lambda *s: torch.randn(*s, dtype=torch.bfloat16) * 0.05)(D, Dh)),
            "wo": _w((lambda *s: torch.randn(*s, dtype=torch.bfloat16) * 0.05)(H * Dh, D)),
        }
    _A_in = _A_setup()

    def _B_setup():
        B, S, D, F = 1, 2048, 512, 1376
        return {
            "x": _w((lambda *s: torch.randn(*s, dtype=torch.bfloat16) * 0.05)(B, S, D)),
            "w1": _w((lambda *s: torch.randn(*s, dtype=torch.bfloat16) * 0.8)(D, F) * (2.0 / D) ** 0.5),
            "w3": _w((lambda *s: torch.randn(*s, dtype=torch.bfloat16) * 0.8)(D, F) * (2.0 / D) ** 0.5),
            "w2": _w((lambda *s: torch.randn(*s, dtype=torch.bfloat16) * 0.8)(F, D) * (2.0 / F) ** 0.5),
        }
    _B_in = _B_setup()

    return {
        "A_x": _A_in["x"],
        "A_wq": _A_in["wq"],
        "A_wk": _A_in["wk"],
        "A_wv": _A_in["wv"],
        "A_wo": _A_in["wo"],
        "B_x": _B_in["x"],
        "B_w1": _B_in["w1"],
        "B_w3": _B_in["w3"],
        "B_w2": _B_in["w2"],
        "gate_w": _w((lambda *s: torch.randn(*s, dtype=torch.bfloat16) * 0.05)(512) * 16.0),
    }

def reference(A_x, A_wq, A_wk, A_wv, A_wo, B_x, B_w1, B_w3, B_w2, gate_w):
    def _A_ref(x, wq, wk, wv, wo):
        B, S, D = x.shape
        H = 32
        Dh = D // H
        q = (lambda x, *d: x.permute(*d))((x @ wq).reshape(B, S, H, Dh), 0, 2, 1, 3)
        k = x @ wk
        v = x @ wv
        scores = torch.einsum("bhqd,bkd->bhqk", q, k) * (Dh ** -0.5)
        p = _softmax(scores, axis=-1)
        o = torch.einsum("bhqk,bkd->bhqd", p, v)
        return (lambda x, *d: x.permute(*d))(o, 0, 2, 1, 3).reshape(B, S, H * Dh) @ wo

    def _B_ref(x, w1, w3, w2):
        gate = torch.einsum("bsd,df->bsf", x, w1)
        up = torch.einsum("bsd,df->bsf", x, w3)
        h = _silu(gate) * up
        out = torch.einsum("bsf,fd->bsd", h, w2)
        return out

    x = A_x
    g = _sigmoid((x * gate_w).sum(-1, keepdims=True))
    a = _A_ref(x, A_wq, A_wk, A_wv, A_wo)
    b = _B_ref(x, B_w1, B_w3, B_w2)
    return g * a + (1 - g) * b
```

```asm
; @launch grid=(256,1,1) block=(512,1,1) lds=163840
.amdgcn_target "amdgcn-amd-amdhsa--gfx950"
.text
.globl gated_mix__grouped_kv_mqa__glu_gated_swiglu__prompt_kernel
.p2align 12
.p2align 8
.type gated_mix__grouped_kv_mqa__glu_gated_swiglu__prompt_kernel,@function
gated_mix__grouped_kv_mqa__glu_gated_swiglu__prompt_kernel:
    s_cmp_ge_u32 s2, 256
    s_cbranch_scc1 L_end
    s_load_dwordx16 s[28:43], s[0:1], 0
    s_load_dwordx2 s[52:53], s[0:1], 72
    v_lshrrev_b32 v1, 6, v0
    s_and_b32 s10, s2, 7
    v_readfirstlane_b32 s3, v1
    v_and_b32 v1, 63, v0
    s_lshr_b32 s11, s2, 3
    s_and_b32 s6, s3, 3
    s_cmp_lt_u32 s3, 4
    s_cbranch_scc1 LA_nopf
    s_getpc_b64 s[74:75]
Lpc_1:
    s_lshl_b32 s65, s6, 5
    s_add_u32 s65, s65, s11
    s_lshl_b32 s65, s65, 7
    v_lshl_add_u32 v125, v1, 14, s65
    v_min_u32 v125, L_end-gated_mix__grouped_kv_mqa__glu_gated_swiglu__prompt_kernel, v125
    s_sub_u32 s74, s74, Lpc_1-gated_mix__grouped_kv_mqa__glu_gated_swiglu__prompt_kernel
    s_subb_u32 s75, s75, 0
    s_mov_b64 exec, 15
    global_load_dword v124, v125, s[74:75]
    s_mov_b64 exec, -1
LA_nopf:
    s_lshr_b32 s67, s10, 2
    s_lshl_b32 s8, s67, 3
    s_and_b32 s9, s11, 7
    s_add_u32 s4, s8, s9
    s_lshl_b32 s8, s10, 2
    s_lshr_b32 s8, 0x2310231, s8
    s_and_b32 s8, s8, 3
    s_lshr_b32 s9, s11, 3
    s_lshl_b32 s5, s8, 2
    s_or_b32 s5, s5, s9
    s_cbranch_scc0 LA_kv
    s_lshr_b32 s7, s3, 2
    s_cbranch_scc1 LA_cpro
    s_setprio 3
    s_add_u32 s65, s9, s4
    s_mov_b32 s62, 0x73625410
    s_mov_b32 s66, 0x37261054
    s_bitcmp1_b32 s65, 1
    s_cmov_b32 s62, 0x73652140
    s_cmov_b32 s66, 0x37216504
    s_bitcmp1_b32 s65, 0
    s_cmov_b32 s62, s66
    s_add_u32 s65, s8, s67
    s_bitcmp1_b32 s65, 0
    s_cselect_b32 s66, 0x11111111, 0
    s_xor_b32 s62, s62, s66
    s_bitcmp1_b32 s8, 1
    s_cselect_b32 s66, 0x22222222, 0
    s_xor_b32 s62, s62, s66
    v_lshrrev_b32 v104, 3, v1
    s_lshl_b32 s65, s4, 17
    v_lshl_add_u32 v104, v104, 10, s65
    v_lshrrev_b32 v105, 4, v1
    v_and_b32 v106, 7, v1
    v_xor_b32 v106, v105, v106
    v_lshl_add_u32 v96, v106, 4, v104
    s_mov_b32 s14, 2097152
    s_mov_b32 s15, 0x00020000
    s_add_u32 s8, s9, s4
    s_and_b32 s8, s8, 2
    s_lshr_b32 s8, s8, 1
    s_mul_i32 s9, s8, 0x2040
    s_lshl_b32 s63, s6, 15
    s_add_u32 s9, s9, s63
    v_xor_b32 v96, s9, v96
    v_xor_b32 v97, 0x2040, v96
    s_lshl_b32 s63, s6, 2
    s_add_u32 s63, s63, s8
    s_lshl_b32 s63, s63, 10
    s_xor_b32 s71, s63, 1024
    v_and_b32 v106, 3, v1
    v_lshlrev_b32 v106, 4, v106
    v_lshrrev_b32 v107, 2, v1
    v_lshl_add_u32 v99, v107, 10, v106
    s_mov_b32 s26, 524288
    s_mov_b32 s27, 0x00020000
    s_mov_b32 s19, 0x00020000
    s_lshl_b32 s48, s6, 14
    s_lshl_b32 s9, s5, 6
    s_add_u32 s48, s48, s9
    v_add_u32 v99, s48, v99
    s_lshl_b32 s48, s6, 10
    s_add_u32 s72, s48, 131072
    s_bitcmp1_b32 s4, 2
    s_cselect_b32 s22, 88064, 0
    s_cselect_b32 s49, 64, 0
    s_lshl_b32 s23, s22, 1
    s_sub_u32 s23, 88064, s23
    s_bfe_u32 s69, s62, 0x30000
    s_add_u32 m0, s63, 0
    s_lshl_b32 s69, s69, 7
    s_waitcnt lgkmcnt(0)
    s_mov_b64 s[12:13], s[28:29]
    buffer_load_dwordx4 v96, s[12:15], s69 offen lds
    s_mov_b64 s[24:25], s[30:31]
    s_bitcmp1_b32 s6, 0
    s_cselect_b64 s[16:17], s[42:43], s[40:41]
    s_lshl_b32 s9, s49, 5
    s_xor_b32 s72, s72, s9
    s_mul_i32 s65, s5, 3
    s_cmp_ge_u32 s5, 15
    s_subb_u32 s65, s65, 3
    s_cmp_ge_u32 s5, 14
    s_cselect_b32 s68, 0, 0xffff
    s_mov_b32 s50, 0x924924
    s_cmov_b32 s50, 0x514514
    s_mul_i32 s48, s6, 3072
    s_add_u32 s64, s48, 49152
    s_mov_b32 s18, 1409024
    v_and_b32 v104, 3, v107
    v_mul_u32_u24 v104, 2752, v104
    s_lshr_b32 s48, s6, 1
    s_mul_i32 s48, s48, 44032
    s_lshl_b32 s9, s65, 6
    s_add_u32 s48, s48, s9
    v_add3_u32 v104, v104, v106, s48
    s_add_u32 m0, s71, 0
    s_nop 0
    buffer_load_dwordx4 v97, s[12:15], s69 offen lds
    v_lshlrev_b32 v105, 1, v105
    s_mov_b32 s51, 0xfea540
    s_mov_b32 s66, 11008
    v_bfe_u32 v106, s51, v105, 2
    v_bfe_u32 v107, s50, v105, 2
    v_mad_u32_u24 v98, v106, s66, v104
    v_and_b32 v106, 2, v106
    v_lshl_add_u32 v98, v107, 6, v98
    v_lshlrev_b32 v106, 4, v106
    v_add_u32 v105, 8, v105
    v_xor_b32 v98, v106, v98
    v_bfe_u32 v106, s51, v105, 2
    s_add_u32 m0, s63, 2048
    s_add_u32 s69, s69, 16384
    buffer_load_dwordx4 v96, s[12:15], s69 offen lds
    v_bfe_u32 v107, s50, v105, 2
    v_mad_u32_u24 v92, v106, s66, v104
    v_and_b32 v106, 2, v106
    v_lshl_add_u32 v92, v107, 6, v92
    v_lshlrev_b32 v106, 4, v106
    v_add_u32 v105, 8, v105
    v_xor_b32 v92, v106, v92
    v_bfe_u32 v106, s51, v105, 2
    v_bfe_u32 v107, s50, v105, 2
    v_mad_u32_u24 v93, v106, s66, v104
    v_and_b32 v106, 2, v106
    v_lshl_add_u32 v93, v107, 6, v93
    s_add_u32 m0, s71, 2048
    s_nop 0
    buffer_load_dwordx4 v97, s[12:15], s69 offen lds
    v_lshlrev_b32 v106, 4, v106
    v_add_u32 v105, 8, v105
    v_xor_b32 v93, v106, v93
    v_lshlrev_b32 v2, 4, v1
    s_bfe_u32 s8, s62, 0x30000
    s_add_u32 m0, s72, 0
    s_lshl_b32 s8, s8, 16
    buffer_load_dwordx4 v99, s[24:27], s8 offen lds
    s_add_u32 m0, s64, 0
    s_bfe_u32 s70, s62, 0x30000
    s_mul_i32 s70, s70, 176128
    s_add_u32 s70, s70, s22
    buffer_load_dwordx4 v98, s[16:19], s70 offen lds
    s_add_u32 m0, s64, 1024
    s_nop 0
    buffer_load_dwordx4 v92, s[16:19], s70 offen lds
    s_add_u32 m0, s64, 2048
    s_nop 0
    buffer_load_dwordx4 v93, s[16:19], s70 offen lds
    s_branch LA_common
LA_cpro:
    s_mul_i32 s65, s5, 3
    s_cmp_ge_u32 s5, 15
    s_subb_u32 s65, s65, 3
    s_cmp_ge_u32 s5, 14
    s_cselect_b32 s68, 0, 0xffff
    s_mov_b32 s14, 2097152
    s_mov_b32 s15, 0x00020000
    v_and_b32 v106, 3, v1
    v_lshlrev_b32 v106, 4, v106
    v_lshrrev_b32 v107, 2, v1
    v_lshl_add_u32 v99, v107, 10, v106
    s_mov_b32 s26, 524288
    s_mov_b32 s27, 0x00020000
    s_mov_b32 s19, 0x00020000
    v_mov_b32 v96, 0
    v_mov_b32 v97, 0
    v_mov_b32 v98, 0
    v_mov_b32 v92, 0
    v_mov_b32 v93, 0
    s_mov_b32 s62, 0
    s_mov_b32 s63, 0
    s_mov_b32 s64, 0
    s_mov_b32 s69, 0
    s_mov_b32 s70, 0
    s_mov_b32 s71, 0
    s_mov_b32 s72, 0
    v_lshlrev_b32 v2, 4, v1
    s_mov_b32 s18, 1409024
    s_waitcnt lgkmcnt(0)
    s_mov_b64 s[12:13], s[28:29]
    s_mov_b64 s[24:25], s[30:31]
    s_mov_b64 s[16:17], s[40:41]
    s_branch LA_common
LA_kv:
    s_lshr_b32 s7, s3, 2
    s_add_u32 s65, s9, s4
    s_mov_b32 s62, 0x73625410
    s_mov_b32 s66, 0x37261054
    s_bitcmp1_b32 s65, 1
    s_cmov_b32 s62, 0x73652140
    s_cmov_b32 s66, 0x37216504
    s_bitcmp1_b32 s65, 0
    s_cmov_b32 s62, s66
    s_add_u32 s65, s8, s67
    s_bitcmp1_b32 s65, 0
    s_cselect_b32 s66, 0x11111111, 0
    s_xor_b32 s62, s62, s66
    s_bitcmp1_b32 s8, 1
    s_cselect_b32 s66, 0x22222222, 0
    s_xor_b32 s62, s62, s66
    v_lshrrev_b32 v104, 3, v1
    s_lshl_b32 s65, s4, 17
    v_lshl_add_u32 v104, v104, 10, s65
    v_lshrrev_b32 v105, 4, v1
    v_and_b32 v106, 7, v1
    v_xor_b32 v106, v105, v106
    v_lshl_add_u32 v96, v106, 4, v104
    s_mov_b32 s14, 2097152
    s_mov_b32 s15, 0x00020000
    v_and_b32 v106, 3, v1
    v_lshlrev_b32 v106, 4, v106
    v_lshrrev_b32 v107, 2, v1
    v_lshl_add_u32 v99, v107, 10, v106
    s_mov_b32 s26, 524288
    s_mov_b32 s27, 0x00020000
    s_mov_b32 s19, 0x00020000
    v_lshlrev_b32 v2, 4, v1
    s_lshl_b32 s8, s3, 14
    v_add_u32 v96, s8, v96
    v_xor_b32 v97, 0x2040, v96
    s_lshl_b32 s63, s3, 11
    s_lshl_b32 s8, s7, 13
    s_lshl_b32 s9, s6, 10
    s_add_u32 s8, s8, s9
    s_add_u32 s64, s8, 0x10000
    v_add_u32 v98, s9, v2
    s_cmp_lt_u32 s6, 2
    s_cselect_b32 s8, -1, 0x70
    s_cselect_b32 s71, 11, 7
    s_cselect_b32 s9, 14, 10
    s_lshl_b32 s18, 1, s9
    v_and_b32 v98, s8, v98
    s_cmp_eq_u32 s7, 0
    s_waitcnt lgkmcnt(0)
    s_mov_b64 s[12:13], s[28:29]
    s_cselect_b64 s[16:17], s[32:33], s[34:35]
    s_cmp_lt_u32 s6, 2
    s_cselect_b64 s[16:17], s[16:17], s[52:53]
    s_bfe_u32 s70, s62, 0x30000
    s_add_u32 m0, s63, 0
    s_lshl_b32 s69, s70, 7
    buffer_load_dwordx4 v96, s[12:15], s69 offen lds
    s_add_u32 m0, s64, 0
    s_lshl_b32 s70, s70, s71
    buffer_load_dwordx4 v98, s[16:19], s70 offen lds
    s_add_u32 m0, s63, 1024
    s_nop 0
    buffer_load_dwordx4 v97, s[12:15], s69 offen lds
    s_mov_b64 s[24:25], s[30:31]
    s_lshl_b32 s8, s3, 2
    s_lshr_b32 s8, s62, s8
    s_and_b32 s8, s8, 7
    s_lshl_b32 s8, s8, 16
    v_add_u32 v99, s8, v99
    v_mov_b32 v92, v1
    v_mov_b32 v93, v1
    s_mov_b32 s68, 0
    s_mov_b32 s72, 0
    s_barrier
    s_bfe_u32 s70, s62, 0x30004
    s_add_u32 m0, s63, 16384
    s_lshl_b32 s69, s70, 7
    buffer_load_dwordx4 v96, s[12:15], s69 offen lds
    s_add_u32 m0, s64, 16384
    s_lshl_b32 s70, s70, s71
    buffer_load_dwordx4 v98, s[16:19], s70 offen lds
    s_add_u32 m0, s63, 17408
    s_nop 0
    buffer_load_dwordx4 v97, s[12:15], s69 offen lds
LA_common:
    s_load_dwordx2 s[28:29], s[0:1], 96
    s_load_dwordx2 s[32:33], s[0:1], 64
    s_load_dwordx2 s[40:41], s[0:1], 80
    s_load_dwordx2 s[44:45], s[0:1], 88
    s_mov_b32 s30, 16777216
    s_mov_b32 s31, 0x00020000
    s_mov_b32 s34, 1409024
    s_mov_b32 s35, 0x00020000
    s_mov_b32 s38, 524288
    s_mov_b32 s39, 0x00020000
    s_mov_b32 s42, 2097152
    s_mov_b32 s43, 0x00020000
    s_mov_b32 s46, 256
    s_mov_b32 s47, 0x00020000
    s_xor_b32 s8, s10, 4
    s_lshl_b32 s8, s8, 2
    s_and_b32 s9, s11, 3
    s_add_u32 s56, s8, s9
    s_lshr_b32 s57, s11, 2
    s_lshl_b32 s58, s3, 10
    s_and_b32 s76, s11, 0
    s_xor_b32 s76, s76, s3
    s_lshl_b32 s73, s9, 15
    s_add_u32 s73, s73, s58
    s_lshl_b32 s8, s4, 2
    s_add_u32 s8, s8, s6
    s_lshl_b32 s59, s8, 11
    s_lshl_b32 s60, s8, 5
    s_lshl_b32 s9, s7, 4
    s_add_u32 s60, s60, s9
    s_add_u32 s60, s60, s5
    s_lshl_b32 s60, s60, 10
    s_add_u32 s60, s60, 12582912
    s_lshl_b32 s8, s4, 5
    s_add_u32 s8, s8, s5
    s_lshl_b32 s8, s8, 2
    s_add_u32 s8, s8, 163840
    s_cmp_eq_u32 s3, 0
    s_cselect_b32 s77, s8, 16777216
    s_mov_b32 s52, 0xbfb8aa3b
    s_mov_b32 s53, 0xbfb8aa3b
    s_mov_b32 s54, 0xffff0000
    s_mov_b32 s55, 0xffff0000
    s_mov_b32 s61, 0x20000
    v_and_b32 v120, 15, v1
    v_lshlrev_b32 v3, 4, v120
    v_lshlrev_b32 v120, 2, v120
    v_bfe_u32 v106, v1, 4, 1
    v_lshl_add_u32 v10, v106, 3, v3
    v_lshrrev_b32 v106, 5, v1
    v_lshl_add_u32 v3, v106, 8, v3
    v_add_u32 v3, 1024, v3
    v_add_u32 v4, 0x10000, v2
    v_add_u32 v5, 0x10000, v3
    v_mov_b32 v8, 0xdddddddd
    v_and_b32 v104, 27, v1
    v_cmp_eq_u32 vcc, 16, v104
    v_mov_b32 v105, 0x3f803f80
    s_lshl_b32 s9, s3, 12
    s_add_u32 s9, s9, 0x20000
    v_cndmask_b32 v68, 0, v105, vcc
    s_bitcmp1_b32 s4, 2
    s_cselect_b32 s22, 88064, 0
    s_cselect_b32 s49, 64, 0
    s_lshl_b32 s23, s22, 1
    s_sub_u32 s23, 88064, s23
    s_cmp_eq_u32 s6, 3
    s_cselect_b32 s20, -1, 0
    s_cselect_b32 s21, 0, 256
    v_lshlrev_b32 v0, 2, v120
    v_mov_b32 v69, v68
    v_mov_b32 v70, v68
    v_mov_b32 v71, v68
    v_mov_b32 v72, v68
    v_mov_b32 v73, v68
    v_mov_b32 v74, v68
    v_mov_b32 v75, v68
    v_mov_b32 v76, v68
    v_mov_b32 v77, v68
    v_mov_b32 v78, v68
    v_mov_b32 v79, v68
    v_mov_b32 v80, v68
    v_mov_b32 v81, v68
    v_mov_b32 v82, v68
    v_mov_b32 v83, v68
    v_mov_b32 v44, 0
    v_mov_b32 v45, 0
    v_mov_b32 v46, 0
    v_mov_b32 v47, 0
    v_mov_b32 v48, 0
    v_mov_b32 v49, 0
    v_mov_b32 v50, 0
    v_mov_b32 v51, 0
    v_mov_b32 v52, 0
    v_mov_b32 v53, 0
    v_mov_b32 v54, 0
    v_mov_b32 v55, 0
    v_mov_b32 v56, 0
    v_mov_b32 v57, 0
    v_mov_b32 v58, 0
    v_mov_b32 v59, 0
    v_lshrrev_b32 v104, 5, v1
    v_lshlrev_b32 v6, 8, v104
    v_bfe_u32 v104, v1, 2, 2
    v_lshl_add_u32 v6, v104, 6, v6
    v_bfe_u32 v104, v1, 4, 1
    v_lshl_add_u32 v6, v104, 5, v6
    v_and_b32 v104, 3, v1
    v_lshl_add_u32 v6, v104, 3, v6
    v_lshl_add_u32 v94, v106, 8, v6
    v_add_u32 v6, s9, v6
    v_add_u32 v9, s9, v94
    s_add_u32 s8, s58, 0x10000
    v_add_u32 v122, s8, v2
    v_and_b32 v123, 0xffffefff, v122
    v_lshrrev_b32 v104, 2, v1
    v_and_b32 v105, 3, v1
    v_lshlrev_b32 v105, 4, v105
    v_lshl_add_u32 v7, v104, 10, v105
    s_lshl_b32 s8, s57, 7
    v_add_u32 v7, s8, v7
    v_mov_b32 v108, -1
    v_mov_b32 v109, -1
    v_mov_b32 v110, -1
    v_mov_b32 v111, -1
    s_waitcnt lgkmcnt(0)
    s_cmp_eq_u32 s5, 0
    s_cbranch_scc1 LA_kv2
    v_lshrrev_b32 v104, 4, v1
    v_and_b32 v105, 15, v1
    v_bfe_u32 v107, v1, 1, 3
    v_xor_b32 v107, v107, v104
    v_lshlrev_b32 v107, 4, v107
    v_lshl_add_u32 v88, v105, 7, v107
    v_and_b32 v107, 0xff, v94
    s_cmp_eq_u32 s7, 0
    s_cbranch_scc0 LA_C
    v_and_b32 v104, 31, v1
    v_lshlrev_b32 v105, 7, v104
    s_lshl_b32 s8, s6, 12
    v_add_u32 v105, s8, v105
    v_bfe_u32 v104, v1, 1, 3
    v_xor_b32 v104, v104, v106
    v_lshl_add_u32 v88, v104, 4, v105
    v_xor_b32 v89, 32, v88
    v_xor_b32 v90, 64, v88
    v_xor_b32 v91, 96, v88
    v_add_u32 v94, 131072, v94
    v_lshlrev_b32 v126, 2, v1
    v_xor_b32 v88, s49, v88
    v_xor_b32 v89, s49, v89
    v_xor_b32 v90, s49, v90
    v_xor_b32 v91, s49, v91
    s_add_u32 m0, s64, 12288
    s_add_u32 s70, s70, s23
    buffer_load_dwordx4 v98, s[16:19], s70 offen lds
    s_add_u32 m0, s64, 13312
    s_nop 0
    buffer_load_dwordx4 v92, s[16:19], s70 offen lds
    s_add_u32 m0, s64, 14336
    s_nop 0
    buffer_load_dwordx4 v93, s[16:19], s70 offen lds
    s_bfe_u32 s69, s62, 0x30004
    s_add_u32 m0, s63, 16384
    s_lshl_b32 s69, s69, 7
    buffer_load_dwordx4 v96, s[12:15], s69 offen lds
    s_add_u32 m0, s71, 16384
    s_nop 0
    buffer_load_dwordx4 v97, s[12:15], s69 offen lds
    s_add_u32 m0, s63, 18432
    s_add_u32 s69, s69, 16384
    buffer_load_dwordx4 v96, s[12:15], s69 offen lds
    s_add_u32 m0, s71, 18432
    s_nop 0
    buffer_load_dwordx4 v97, s[12:15], s69 offen lds
    s_bfe_u32 s8, s62, 0x30004
    s_add_u32 m0, s72, 4096
    s_lshl_b32 s8, s8, 16
    s_waitcnt vmcnt(7)
    s_barrier
    buffer_load_dwordx4 v99, s[24:27], s8 offen lds
    s_add_u32 m0, s64, 24576
    s_bfe_u32 s70, s62, 0x30004
    s_mul_i32 s70, s70, 176128
    s_add_u32 s70, s70, s22
    buffer_load_dwordx4 v98, s[16:19], s70 offen lds
    ds_read_b128 v[128:131], v88 offset:0
    ds_read_b128 v[132:135], v89 offset:0
    ds_read_b64_tr_b16 v[12:13], v94 offset:0
    ds_read_b64_tr_b16 v[14:15], v94 offset:256
    ds_read_b64_tr_b16 v[16:17], v94 offset:1024
    ds_read_b64_tr_b16 v[18:19], v94 offset:1280
    s_add_u32 m0, s64, 25600
    s_nop 0
    buffer_load_dwordx4 v92, s[16:19], s70 offen lds
    s_add_u32 m0, s64, 26624
    s_nop 0
    buffer_load_dwordx4 v93, s[16:19], s70 offen lds
    s_bfe_u32 s69, s62, 0x30008
    s_add_u32 m0, s63, 32768
    s_lshl_b32 s69, s69, 7
    buffer_load_dwordx4 v96, s[12:15], s69 offen lds
    s_waitcnt lgkmcnt(0)
    v_mfma_f32_32x32x16_bf16 v[28:43], v[12:15], v[128:131], 0
    v_mfma_f32_32x32x16_bf16 v[28:43], v[16:19], v[132:135], v[28:43]
    s_add_u32 m0, s64, 36864
    s_add_u32 s70, s70, s23
    s_waitcnt vmcnt(9)
    s_barrier
    buffer_load_dwordx4 v98, s[16:19], s70 offen lds
    s_add_u32 m0, s64, 37888
    s_nop 0
    buffer_load_dwordx4 v92, s[16:19], s70 offen lds
    ds_read_b128 v[136:139], v90 offset:0
    ds_read_b128 v[140:143], v91 offset:0
    ds_read_b64_tr_b16 v[12:13], v94 offset:2048
    ds_read_b64_tr_b16 v[14:15], v94 offset:2304
    ds_read_b64_tr_b16 v[16:17], v94 offset:3072
    ds_read_b64_tr_b16 v[18:19], v94 offset:3328
    s_add_u32 m0, s64, 38912
    s_nop 0
    buffer_load_dwordx4 v93, s[16:19], s70 offen lds
    s_add_u32 m0, s71, 32768
    s_nop 0
    buffer_load_dwordx4 v97, s[12:15], s69 offen lds
    s_add_u32 m0, s63, 34816
    s_add_u32 s69, s69, 16384
    buffer_load_dwordx4 v96, s[12:15], s69 offen lds
    s_add_u32 m0, s71, 34816
    s_nop 0
    buffer_load_dwordx4 v97, s[12:15], s69 offen lds
    s_waitcnt lgkmcnt(0)
    v_mfma_f32_32x32x16_bf16 v[28:43], v[12:15], v[136:139], v[28:43]
    v_mfma_f32_32x32x16_bf16 v[28:43], v[16:19], v[140:143], v[28:43]
    s_bfe_u32 s8, s62, 0x30008
    s_add_u32 m0, s72, 8192
    s_lshl_b32 s8, s8, 16
    s_waitcnt vmcnt(7)
    s_barrier
    buffer_load_dwordx4 v99, s[24:27], s8 offen lds
    s_add_u32 m0, s64, 0
    s_bfe_u32 s70, s62, 0x30008
    s_mul_i32 s70, s70, 176128
    s_add_u32 s70, s70, s22
    buffer_load_dwordx4 v98, s[16:19], s70 offen lds
    ds_read_b128 v[144:147], v88 offset:16384
    ds_read_b128 v[148:151], v89 offset:16384
    ds_read_b64_tr_b16 v[12:13], v94 offset:4096
    ds_read_b64_tr_b16 v[14:15], v94 offset:4352
    ds_read_b64_tr_b16 v[16:17], v94 offset:5120
    ds_read_b64_tr_b16 v[18:19], v94 offset:5376
    s_add_u32 m0, s64, 1024
    s_nop 0
    buffer_load_dwordx4 v92, s[16:19], s70 offen lds
    s_add_u32 m0, s64, 2048
    s_nop 0
    buffer_load_dwordx4 v93, s[16:19], s70 offen lds
    s_bfe_u32 s69, s62, 0x3000c
    s_add_u32 m0, s63, 0
    s_lshl_b32 s69, s69, 7
    buffer_load_dwordx4 v96, s[12:15], s69 offen lds
    s_waitcnt lgkmcnt(0)
    v_mfma_f32_32x32x16_bf16 v[28:43], v[12:15], v[144:147], v[28:43]
    v_mfma_f32_32x32x16_bf16 v[28:43], v[16:19], v[148:151], v[28:43]
    s_add_u32 m0, s64, 12288
    s_add_u32 s70, s70, s23
    s_waitcnt vmcnt(8)
    s_barrier
    buffer_load_dwordx4 v98, s[16:19], s70 offen lds
    s_add_u32 m0, s64, 13312
    s_nop 0
    buffer_load_dwordx4 v92, s[16:19], s70 offen lds
    ds_read_b128 v[152:155], v90 offset:16384
    ds_read_b128 v[156:159], v91 offset:16384
    ds_read_b64_tr_b16 v[12:13], v94 offset:6144
    ds_read_b64_tr_b16 v[14:15], v94 offset:6400
    ds_read_b64_tr_b16 v[16:17], v94 offset:7168
    ds_read_b64_tr_b16 v[18:19], v94 offset:7424
    s_add_u32 m0, s64, 14336
    s_nop 0
    buffer_load_dwordx4 v93, s[16:19], s70 offen lds
    s_add_u32 m0, s71, 0
    s_nop 0
    buffer_load_dwordx4 v97, s[12:15], s69 offen lds
    s_add_u32 m0, s63, 2048
    s_add_u32 s69, s69, 16384
    buffer_load_dwordx4 v96, s[12:15], s69 offen lds
    s_add_u32 m0, s71, 2048
    s_nop 0
    buffer_load_dwordx4 v97, s[12:15], s69 offen lds
    s_waitcnt lgkmcnt(0)
    v_mfma_f32_32x32x16_bf16 v[28:43], v[12:15], v[152:155], v[28:43]
    v_mfma_f32_32x32x16_bf16 v[28:43], v[16:19], v[156:159], v[28:43]
    s_add_u32 m0, s64, 24576
    s_bfe_u32 s70, s62, 0x3000c
    s_mul_i32 s70, s70, 176128
    s_add_u32 s70, s70, s22
    s_waitcnt vmcnt(7)
    s_barrier
    buffer_load_dwordx4 v98, s[16:19], s70 offen lds
    s_add_u32 m0, s64, 25600
    s_nop 0
    buffer_load_dwordx4 v92, s[16:19], s70 offen lds
    ds_read_b128 v[160:163], v88 offset:32768
    ds_read_b128 v[164:167], v89 offset:32768
    ds_read_b64_tr_b16 v[12:13], v94 offset:8192
    ds_read_b64_tr_b16 v[14:15], v94 offset:8448
    ds_read_b64_tr_b16 v[16:17], v94 offset:9216
    ds_read_b64_tr_b16 v[18:19], v94 offset:9472
    s_add_u32 m0, s64, 26624
    s_nop 0
    buffer_load_dwordx4 v93, s[16:19], s70 offen lds
    s_bfe_u32 s69, s62, 0x30010
    s_add_u32 m0, s63, 16384
    s_lshl_b32 s69, s69, 7
    buffer_load_dwordx4 v96, s[12:15], s69 offen lds
    s_add_u32 m0, s71, 16384
    s_nop 0
    buffer_load_dwordx4 v97, s[12:15], s69 offen lds
    s_waitcnt lgkmcnt(0)
    v_mfma_f32_32x32x16_bf16 v[28:43], v[12:15], v[160:163], v[28:43]
    v_mfma_f32_32x32x16_bf16 v[28:43], v[16:19], v[164:167], v[28:43]
    s_add_u32 m0, s64, 36864
    s_add_u32 s70, s70, s23
    s_waitcnt vmcnt(8)
    s_barrier
    buffer_load_dwordx4 v98, s[16:19], s70 offen lds
    s_add_u32 m0, s64, 37888
    s_nop 0
    buffer_load_dwordx4 v92, s[16:19], s70 offen lds
    ds_read_b128 v[168:171], v90 offset:32768
    ds_read_b128 v[172:175], v91 offset:32768
    ds_read_b64_tr_b16 v[12:13], v94 offset:10240
    ds_read_b64_tr_b16 v[14:15], v94 offset:10496
    ds_read_b64_tr_b16 v[16:17], v94 offset:11264
    ds_read_b64_tr_b16 v[18:19], v94 offset:11520
    s_add_u32 m0, s64, 38912
    s_nop 0
    buffer_load_dwordx4 v93, s[16:19], s70 offen lds
    s_add_u32 m0, s63, 18432
    s_add_u32 s69, s69, 16384
    buffer_load_dwordx4 v96, s[12:15], s69 offen lds
    s_add_u32 m0, s71, 18432
    s_nop 0
    buffer_load_dwordx4 v97, s[12:15], s69 offen lds
    s_waitcnt lgkmcnt(0)
    v_mfma_f32_32x32x16_bf16 v[28:43], v[12:15], v[168:171], v[28:43]
    v_mfma_f32_32x32x16_bf16 v[28:43], v[16:19], v[172:175], v[28:43]
    s_add_u32 m0, s64, 0
    s_bfe_u32 s70, s62, 0x30010
    s_mul_i32 s70, s70, 176128
    s_add_u32 s70, s70, s22
    s_waitcnt vmcnt(7)
    s_barrier
    s_setprio 1
    buffer_load_dwordx4 v98, s[16:19], s70 offen lds
    s_add_u32 m0, s64, 1024
    s_nop 0
    buffer_load_dwordx4 v92, s[16:19], s70 offen lds
    ds_read_b128 v[176:179], v88 offset:0
    ds_read_b128 v[180:183], v89 offset:0
    s_add_u32 m0, s64, 2048
    s_nop 0
    buffer_load_dwordx4 v93, s[16:19], s70 offen lds
    s_bfe_u32 s69, s62, 0x30014
    s_add_u32 m0, s63, 32768
    s_lshl_b32 s69, s69, 7
    buffer_load_dwordx4 v96, s[12:15], s69 offen lds
    s_add_u32 m0, s71, 32768
    s_nop 0
    buffer_load_dwordx4 v97, s[12:15], s69 offen lds
    s_waitcnt lgkmcnt(0)
    s_add_u32 m0, s64, 12288
    s_add_u32 s70, s70, s23
    s_waitcnt vmcnt(7)
    s_barrier
    buffer_load_dwordx4 v98, s[16:19], s70 offen lds
    s_add_u32 m0, s64, 13312
    s_nop 0
    buffer_load_dwordx4 v92, s[16:19], s70 offen lds
    ds_read_b128 v[184:187], v90 offset:0
    ds_read_b128 v[188:191], v91 offset:0
    s_add_u32 m0, s64, 14336
    s_nop 0
    buffer_load_dwordx4 v93, s[16:19], s70 offen lds
    s_add_u32 m0, s63, 34816
    s_add_u32 s69, s69, 16384
    buffer_load_dwordx4 v96, s[12:15], s69 offen lds
    s_add_u32 m0, s71, 34816
    s_nop 0
    buffer_load_dwordx4 v97, s[12:15], s69 offen lds
    s_waitcnt lgkmcnt(0)
    s_add_u32 m0, s64, 24576
    s_bfe_u32 s70, s62, 0x30014
    s_mul_i32 s70, s70, 176128
    s_add_u32 s70, s70, s22
    s_waitcnt vmcnt(7)
    s_barrier
    buffer_load_dwordx4 v98, s[16:19], s70 offen lds
    s_add_u32 m0, s64, 25600
    s_nop 0
    buffer_load_dwordx4 v92, s[16:19], s70 offen lds
    ds_read_b128 v[192:195], v88 offset:16384
    ds_read_b128 v[196:199], v89 offset:16384
    s_add_u32 m0, s64, 26624
    s_nop 0
    buffer_load_dwordx4 v93, s[16:19], s70 offen lds
    s_bfe_u32 s69, s62, 0x30018
    s_add_u32 m0, s63, 0
    s_lshl_b32 s69, s69, 7
    buffer_load_dwordx4 v96, s[12:15], s69 offen lds
    s_add_u32 m0, s71, 0
    s_nop 0
    buffer_load_dwordx4 v97, s[12:15], s69 offen lds
    s_waitcnt lgkmcnt(0)
    s_add_u32 m0, s64, 36864
    s_add_u32 s70, s70, s23
    s_waitcnt vmcnt(7)
    s_barrier
    buffer_load_dwordx4 v98, s[16:19], s70 offen lds
    s_add_u32 m0, s64, 37888
    s_nop 0
    buffer_load_dwordx4 v92, s[16:19], s70 offen lds
    ds_read_b128 v[200:203], v90 offset:16384
    ds_read_b128 v[204:207], v91 offset:16384
    s_add_u32 m0, s64, 38912
    s_nop 0
    buffer_load_dwordx4 v93, s[16:19], s70 offen lds
    s_add_u32 m0, s63, 2048
    s_add_u32 s69, s69, 16384
    buffer_load_dwordx4 v96, s[12:15], s69 offen lds
    s_add_u32 m0, s71, 2048
    s_nop 0
    buffer_load_dwordx4 v97, s[12:15], s69 offen lds
    s_waitcnt lgkmcnt(0)
    s_add_u32 m0, s64, 0
    s_bfe_u32 s70, s62, 0x30018
    s_mul_i32 s70, s70, 176128
    s_add_u32 s70, s70, s22
    s_waitcnt vmcnt(7)
    s_barrier
    buffer_load_dwordx4 v98, s[16:19], s70 offen lds
    s_add_u32 m0, s64, 1024
    s_nop 0
    buffer_load_dwordx4 v92, s[16:19], s70 offen lds
    ds_read_b128 v[208:211], v88 offset:32768
    ds_read_b128 v[212:215], v89 offset:32768
    s_add_u32 m0, s64, 2048
    s_nop 0
    buffer_load_dwordx4 v93, s[16:19], s70 offen lds
    s_bfe_u32 s69, s62, 0x3001c
    s_add_u32 m0, s63, 16384
    s_lshl_b32 s69, s69, 7
    buffer_load_dwordx4 v96, s[12:15], s69 offen lds
    s_add_u32 m0, s71, 16384
    s_nop 0
    buffer_load_dwordx4 v97, s[12:15], s69 offen lds
    s_waitcnt lgkmcnt(0)
    s_add_u32 m0, s64, 12288
    s_add_u32 s70, s70, s23
    s_waitcnt vmcnt(7)
    s_barrier
    buffer_load_dwordx4 v98, s[16:19], s70 offen lds
    s_add_u32 m0, s64, 13312
    s_nop 0
    buffer_load_dwordx4 v92, s[16:19], s70 offen lds
    ds_read_b128 v[216:219], v90 offset:32768
    ds_read_b128 v[220:223], v91 offset:32768
    s_add_u32 m0, s64, 14336
    s_nop 0
    buffer_load_dwordx4 v93, s[16:19], s70 offen lds
    s_add_u32 m0, s63, 18432
    s_add_u32 s69, s69, 16384
    buffer_load_dwordx4 v96, s[12:15], s69 offen lds
    s_add_u32 m0, s71, 18432
    s_nop 0
    buffer_load_dwordx4 v97, s[12:15], s69 offen lds
    s_waitcnt lgkmcnt(0)
    s_waitcnt vmcnt(7)
    s_barrier
    buffer_load_dword v121, v0, s[44:47], s21 offen sc1
    s_add_u32 m0, s64, 24576
    s_bfe_u32 s70, s62, 0x3001c
    s_mul_i32 s70, s70, 176128
    s_add_u32 s70, s70, s22
    buffer_load_dwordx4 v98, s[16:19], s70 offen lds
    ds_read_b128 v[224:227], v88 offset:0
    ds_read_b128 v[228:231], v89 offset:0
    s_add_u32 m0, s64, 25600
    s_nop 0
    buffer_load_dwordx4 v92, s[16:19], s70 offen lds
    s_add_u32 m0, s64, 26624
    s_nop 0
    buffer_load_dwordx4 v93, s[16:19], s70 offen lds
    s_waitcnt lgkmcnt(0)
    s_add_u32 m0, s64, 36864
    s_add_u32 s70, s70, s23
    s_waitcnt vmcnt(6)
    s_barrier
    buffer_load_dwordx4 v98, s[16:19], s70 offen lds
    s_add_u32 m0, s64, 37888
    s_nop 0
    buffer_load_dwordx4 v92, s[16:19], s70 offen lds
    ds_read_b128 v[232:235], v90 offset:0
    ds_read_b128 v[236:239], v91 offset:0
    s_add_u32 m0, s64, 38912
    s_nop 0
    buffer_load_dwordx4 v93, s[16:19], s70 offen lds
    s_waitcnt lgkmcnt(0)
    s_waitcnt vmcnt(3)
    v_cmp_ne_u32 vcc, v8, v121
    s_and_b32 s8, vcc_lo, s20
    s_cbranch_scc1 Lpoll_2
Lpok_3:
    s_barrier
    s_lshl_b32 s8, s6, 8
    s_add_u32 m0, s8, 32768
    s_lshr_b32 s8, s59, 2
    s_add_u32 s8, s8, 131072
    buffer_load_dword v126, s[28:31], s8 offen sc1 lds
    s_bfe_u32 s8, s62, 0x3000c
    s_add_u32 m0, s72, 12288
    s_lshl_b32 s8, s8, 16
    buffer_load_dwordx4 v99, s[24:27], s8 offen lds
    ds_read_b128 v[240:243], v88 offset:16384
    ds_read_b128 v[244:247], v89 offset:16384
    s_bfe_u32 s8, s62, 0x30010
    s_add_u32 m0, s72, 16384
    s_lshl_b32 s8, s8, 16
    buffer_load_dwordx4 v99, s[24:27], s8 offen lds
    s_bfe_u32 s8, s62, 0x30014
    s_add_u32 m0, s72, 20480
    s_lshl_b32 s8, s8, 16
    buffer_load_dwordx4 v99, s[24:27], s8 offen lds
    s_bfe_u32 s8, s62, 0x30018
    s_add_u32 m0, s72, 24576
    s_lshl_b32 s8, s8, 16
    buffer_load_dwordx4 v99, s[24:27], s8 offen lds
    s_bfe_u32 s8, s62, 0x3001c
    s_add_u32 m0, s72, 28672
    s_lshl_b32 s8, s8, 16
    buffer_load_dwordx4 v99, s[24:27], s8 offen lds
    s_waitcnt lgkmcnt(0)
    s_waitcnt vmcnt(6)
    s_barrier
    s_add_u32 s8, s73, 98304
    s_add_u32 m0, s58, 98304
    s_and_b32 s8, s8, 0x1ffff
    buffer_load_dwordx4 v2, s[28:31], s8 offen sc1 lds
    s_add_u32 s8, s73, 102400
    s_add_u32 m0, s58, 102400
    s_and_b32 s8, s8, 0x1ffff
    buffer_load_dwordx4 v2, s[28:31], s8 offen sc1 lds
    ds_read_b128 v[248:251], v90 offset:16384
    ds_read_b128 v[252:255], v91 offset:16384
    s_add_u32 s8, s73, 106496
    s_add_u32 m0, s58, 106496
    s_and_b32 s8, s8, 0x1ffff
    buffer_load_dwordx4 v2, s[28:31], s8 offen sc1 lds
    s_add_u32 s8, s73, 110592
    s_add_u32 m0, s58, 110592
    s_and_b32 s8, s8, 0x1ffff
    buffer_load_dwordx4 v2, s[28:31], s8 offen sc1 lds
    s_add_u32 s8, s73, 114688
    s_add_u32 m0, s58, 114688
    s_and_b32 s8, s8, 0x1ffff
    buffer_load_dwordx4 v2, s[28:31], s8 offen sc1 lds
    s_add_u32 s8, s73, 118784
    s_add_u32 m0, s58, 118784
    s_and_b32 s8, s8, 0x1ffff
    buffer_load_dwordx4 v2, s[28:31], s8 offen sc1 lds
    s_add_u32 s8, s73, 122880
    s_add_u32 m0, s58, 122880
    s_and_b32 s8, s8, 0x1ffff
    buffer_load_dwordx4 v2, s[28:31], s8 offen sc1 lds
    s_add_u32 s8, s73, 126976
    s_add_u32 m0, s58, 126976
    s_and_b32 s8, s8, 0x1ffff
    buffer_load_dwordx4 v2, s[28:31], s8 offen sc1 lds
    s_waitcnt lgkmcnt(0)
    s_waitcnt vmcnt(8)
    s_barrier
    s_setprio 3
    ds_read_b64_tr_b16 v[12:13], v94 offset:12288
    ds_read_b64_tr_b16 v[14:15], v94 offset:12544
    ds_read_b64_tr_b16 v[16:17], v94 offset:13312
    ds_read_b64_tr_b16 v[18:19], v94 offset:13568
    ds_read_b64_tr_b16 v[20:21], v94 offset:14336
    ds_read_b64_tr_b16 v[22:23], v94 offset:14592
    ds_read_b64_tr_b16 v[24:25], v94 offset:15360
    ds_read_b64_tr_b16 v[26:27], v94 offset:15616
    s_waitcnt lgkmcnt(4)
    v_mfma_f32_32x32x16_bf16 v[28:43], v[12:15], v[176:179], v[28:43]
    ds_read_b64_tr_b16 v[60:61], v94 offset:16384
    ds_read_b64_tr_b16 v[62:63], v94 offset:16640
    ds_read_b64_tr_b16 v[64:65], v94 offset:17408
    ds_read_b64_tr_b16 v[66:67], v94 offset:17664
    v_mfma_f32_32x32x16_bf16 v[28:43], v[16:19], v[180:183], v[28:43]
    s_add_u32 s8, s60, 0
    buffer_store_dwordx4 v[108:111], v2, s[28:31], s8 offen sc1
    s_waitcnt lgkmcnt(4)
    v_mfma_f32_32x32x16_bf16 v[28:43], v[20:23], v[184:187], v[28:43]
    ds_read_b64_tr_b16 v[12:13], v94 offset:18432
    ds_read_b64_tr_b16 v[14:15], v94 offset:18688
    ds_read_b64_tr_b16 v[16:17], v94 offset:19456
    ds_read_b64_tr_b16 v[18:19], v94 offset:19712
    v_mfma_f32_32x32x16_bf16 v[28:43], v[24:27], v[188:191], v[28:43]
    s_add_u32 s8, s60, 16384
    buffer_store_dwordx4 v[108:111], v2, s[28:31], s8 offen sc1
    s_waitcnt lgkmcnt(4)
    v_mfma_f32_32x32x16_bf16 v[28:43], v[60:63], v[192:195], v[28:43]
    ds_read_b64_tr_b16 v[20:21], v94 offset:20480
    ds_read_b64_tr_b16 v[22:23], v94 offset:20736
    ds_read_b64_tr_b16 v[24:25], v94 offset:21504
    ds_read_b64_tr_b16 v[26:27], v94 offset:21760
    v_mfma_f32_32x32x16_bf16 v[28:43], v[64:67], v[196:199], v[28:43]
    s_add_u32 s8, s73, 0
    s_add_u32 m0, s58, 0
    s_and_b32 s8, s8, 0x1ffff
    buffer_load_dwordx4 v2, s[28:31], s8 offen sc1 lds
    s_waitcnt lgkmcnt(4)
    v_mfma_f32_32x32x16_bf16 v[28:43], v[12:15], v[200:203], v[28:43]
    ds_read_b64_tr_b16 v[60:61], v94 offset:22528
    ds_read_b64_tr_b16 v[62:63], v94 offset:22784
    ds_read_b64_tr_b16 v[64:65], v94 offset:23552
    ds_read_b64_tr_b16 v[66:67], v94 offset:23808
    v_mfma_f32_32x32x16_bf16 v[28:43], v[16:19], v[204:207], v[28:43]
    s_add_u32 s8, s73, 4096
    s_add_u32 m0, s58, 4096
    s_and_b32 s8, s8, 0x1ffff
    buffer_load_dwordx4 v2, s[28:31], s8 offen sc1 lds
    s_waitcnt lgkmcnt(4)
    v_mfma_f32_32x32x16_bf16 v[28:43], v[20:23], v[208:211], v[28:43]
    ds_read_b64_tr_b16 v[12:13], v94 offset:24576
    ds_read_b64_tr_b16 v[14:15], v94 offset:24832
    ds_read_b64_tr_b16 v[16:17], v94 offset:25600
    ds_read_b64_tr_b16 v[18:19], v94 offset:25856
    v_mfma_f32_32x32x16_bf16 v[28:43], v[24:27], v[212:215], v[28:43]
    s_add_u32 s8, s73, 8192
    s_add_u32 m0, s58, 8192
    s_and_b32 s8, s8, 0x1ffff
    buffer_load_dwordx4 v2, s[28:31], s8 offen sc1 lds
    s_waitcnt lgkmcnt(4)
    v_mfma_f32_32x32x16_bf16 v[28:43], v[60:63], v[216:219], v[28:43]
    ds_read_b64_tr_b16 v[20:21], v94 offset:26624
    ds_read_b64_tr_b16 v[22:23], v94 offset:26880
    ds_read_b64_tr_b16 v[24:25], v94 offset:27648
    ds_read_b64_tr_b16 v[26:27], v94 offset:27904
    v_mfma_f32_32x32x16_bf16 v[28:43], v[64:67], v[220:223], v[28:43]
    s_add_u32 s8, s73, 12288
    s_add_u32 m0, s58, 12288
    s_and_b32 s8, s8, 0x1ffff
    buffer_load_dwordx4 v2, s[28:31], s8 offen sc1 lds
    s_waitcnt lgkmcnt(4)
    v_mfma_f32_32x32x16_bf16 v[28:43], v[12:15], v[224:227], v[28:43]
    ds_read_b64_tr_b16 v[60:61], v94 offset:28672
    ds_read_b64_tr_b16 v[62:63], v94 offset:28928
    ds_read_b64_tr_b16 v[64:65], v94 offset:29696
    ds_read_b64_tr_b16 v[66:67], v94 offset:29952
    v_mfma_f32_32x32x16_bf16 v[28:43], v[16:19], v[228:231], v[28:43]
    s_add_u32 s8, s73, 16384
    s_add_u32 m0, s58, 16384
    s_and_b32 s8, s8, 0x1ffff
    buffer_load_dwordx4 v2, s[28:31], s8 offen sc1 lds
    s_waitcnt lgkmcnt(4)
    v_mfma_f32_32x32x16_bf16 v[28:43], v[20:23], v[232:235], v[28:43]
    ds_read_b64_tr_b16 v[12:13], v94 offset:30720
    ds_read_b64_tr_b16 v[14:15], v94 offset:30976
    ds_read_b64_tr_b16 v[16:17], v94 offset:31744
    ds_read_b64_tr_b16 v[18:19], v94 offset:32000
    v_mfma_f32_32x32x16_bf16 v[28:43], v[24:27], v[236:239], v[28:43]
    s_add_u32 s8, s73, 20480
    s_add_u32 m0, s58, 20480
    s_and_b32 s8, s8, 0x1ffff
    buffer_load_dwordx4 v2, s[28:31], s8 offen sc1 lds
    s_waitcnt lgkmcnt(4)
    v_mfma_f32_32x32x16_bf16 v[28:43], v[60:63], v[240:243], v[28:43]
    v_mfma_f32_32x32x16_bf16 v[28:43], v[64:67], v[244:247], v[28:43]
    s_add_u32 s8, s73, 24576
    s_add_u32 m0, s58, 24576
    s_and_b32 s8, s8, 0x1ffff
    buffer_load_dwordx4 v2, s[28:31], s8 offen sc1 lds
    s_waitcnt lgkmcnt(0)
    v_mfma_f32_32x32x16_bf16 v[28:43], v[12:15], v[248:251], v[28:43]
    v_mfma_f32_32x32x16_bf16 v[28:43], v[16:19], v[252:255], v[28:43]
    s_add_u32 s8, s73, 28672
    s_add_u32 m0, s58, 28672
    s_and_b32 s8, s8, 0x1ffff
    buffer_load_dwordx4 v2, s[28:31], s8 offen sc1 lds
    s_nop 9
    s_nop 1
    v_cvt_pk_bf16_f32 v28, v28, v29
    v_cvt_pk_bf16_f32 v29, v30, v31
    v_cvt_pk_bf16_f32 v30, v32, v33
    v_cvt_pk_bf16_f32 v31, v34, v35
    v_cvt_pk_bf16_f32 v32, v36, v37
    v_cvt_pk_bf16_f32 v33, v38, v39
    v_cvt_pk_bf16_f32 v34, v40, v41
    v_cvt_pk_bf16_f32 v35, v42, v43
    ds_write_b128 v123, v[28:31]
    ds_write_b128 v123, v[32:35] offset:4096
    s_waitcnt vmcnt(10)
LA_join2:
    s_waitcnt lgkmcnt(0)
    s_barrier
    ds_read_b128 v[84:87], v122
    ds_read_b128 v[60:63], v4 offset:32768
    s_mov_b32 s54, 0x0000ffff
    s_mov_b32 s55, 0x0000ffff
    ds_read_b128 v[64:67], v4 offset:34816
    s_mov_b64 exec, s[54:55]
    ds_read_b128 v[68:71], v5 offset:32768
    ds_read_b128 v[72:75], v5 offset:33280
    s_mov_b64 exec, -1
    s_waitcnt lgkmcnt(3)
    v_mfma_f32_32x32x16_bf16 v[12:27], v[60:63], v[84:87], 0
    s_branch LA_join
Lpoll_2:
    s_cmp_eq_u32 s61, 0
    s_cbranch_scc1 Lpok_3
    s_sub_u32 s61, s61, 1
    s_sleep 8
    buffer_load_dword v121, v0, s[44:47], 0 offen sc1
    s_waitcnt vmcnt(0)
    v_cmp_ne_u32 vcc, v8, v121
    s_cbranch_vccnz Lpoll_2
    s_branch Lpok_3
LA_C:
    s_and_b32 s8, s3, 1
    s_lshl_b32 s9, s8, 13
    v_add_u32 v88, s9, v88
    v_xor_b32 v89, 64, v88
    s_lshl_b32 s9, s4, 1
    s_add_u32 s8, s8, s9
    s_mul_i32 s8, s8, 86
    s_add_u32 s65, s65, s8
    s_lshl_b32 s65, s65, 11
    s_add_u32 s65, s65, 4194304
    v_and_b32 v105, 1, v104
    v_mul_u32_u24 v105, 1536, v105
    v_mul_u32_u24 v106, 6144, v106
    v_add3_u32 v107, v107, v105, v106
    s_cmp_eq_u32 s68, 0
    s_cselect_b32 s9, 2, 3
    s_lshr_b32 s8, s6, 1
    s_mul_i32 s9, s9, s8
    s_lshl_b32 s8, s9, 10
    s_add_u32 s65, s65, s8
    s_add_u32 s66, s65, 88064
    s_and_b32 s8, s9, 1
    s_lshl_b32 s8, s8, 5
    v_xor_b32 v90, s8, v107
    s_lshr_b32 s8, s9, 1
    s_lshl_b32 s8, s8, 8
    s_add_u32 s8, s8, 49152
    v_add_u32 v90, s8, v90
    s_add_u32 s9, s9, 1
    s_and_b32 s8, s9, 1
    s_lshl_b32 s8, s8, 5
    v_xor_b32 v91, s8, v107
    s_lshr_b32 s8, s9, 1
    s_lshl_b32 s8, s8, 8
    s_add_u32 s8, s8, 49152
    v_add_u32 v91, s8, v91
    s_add_u32 s9, s9, 1
    s_and_b32 s8, s9, 1
    s_lshl_b32 s8, s8, 5
    v_xor_b32 v92, s8, v107
    s_lshr_b32 s8, s9, 1
    s_lshl_b32 s8, s8, 8
    s_add_u32 s8, s8, 49152
    v_add_u32 v92, s8, v92
    s_cmp_eq_u32 s68, 0
    s_cbranch_scc1 LA_N2
    s_setprio 2
    v_xor_b32 v88, s49, v88
    v_xor_b32 v89, s49, v89
    s_and_b32 s9, s3, 1
    s_lshl_b32 s9, s9, 9
    v_lshl_add_u32 v126, v120, 2, s9
    s_barrier
    ds_read_b128 v[224:227], v88 offset:0
    ds_read_b64_tr_b16 v[12:13], v90 offset:0
    ds_read_b64_tr_b16 v[14:15], v90 offset:768
    ds_read_b128 v[228:231], v88 offset:2048
    ds_read_b128 v[232:235], v88 offset:4096
    ds_read_b128 v[236:239], v88 offset:6144
    ds_read_b64_tr_b16 v[16:17], v90 offset:3072
    ds_read_b64_tr_b16 v[18:19], v90 offset:3840
    ds_read_b64_tr_b16 v[20:21], v91 offset:0
    ds_read_b64_tr_b16 v[22:23], v91 offset:768
    s_waitcnt lgkmcnt(7)
    v_mfma_f32_16x16x32_bf16 v[128:131], v[12:15], v[224:227], 0
    ds_read_b64_tr_b16 v[24:25], v91 offset:3072
    s_waitcnt lgkmcnt(7)
    v_mfma_f32_16x16x32_bf16 v[132:135], v[12:15], v[228:231], 0
    ds_read_b64_tr_b16 v[26:27], v91 offset:3840
    s_waitcnt lgkmcnt(7)
    v_mfma_f32_16x16x32_bf16 v[136:139], v[12:15], v[232:235], 0
    ds_read_b128 v[240:243], v89 offset:0
    s_waitcnt lgkmcnt(7)
    v_mfma_f32_16x16x32_bf16 v[140:143], v[12:15], v[236:239], 0
    ds_read_b128 v[244:247], v89 offset:2048
    s_waitcnt lgkmcnt(6)
    v_mfma_f32_16x16x32_bf16 v[156:159], v[16:19], v[236:239], 0
    ds_read_b64_tr_b16 v[12:13], v92 offset:0
    v_mfma_f32_16x16x32_bf16 v[152:155], v[16:19], v[232:235], 0
    ds_read_b64_tr_b16 v[14:15], v92 offset:768
    v_mfma_f32_16x16x32_bf16 v[148:151], v[16:19], v[228:231], 0
    ds_read_b128 v[248:251], v89 offset:4096
    v_mfma_f32_16x16x32_bf16 v[144:147], v[16:19], v[224:227], 0
    ds_read_b128 v[252:255], v89 offset:6144
    s_waitcnt lgkmcnt(8)
    v_mfma_f32_16x16x32_bf16 v[160:163], v[20:23], v[224:227], 0
    ds_read_b64_tr_b16 v[16:17], v92 offset:3072
    v_mfma_f32_16x16x32_bf16 v[164:167], v[20:23], v[228:231], 0
    ds_read_b64_tr_b16 v[18:19], v92 offset:3840
    v_mfma_f32_16x16x32_bf16 v[168:171], v[20:23], v[232:235], 0
    v_mfma_f32_16x16x32_bf16 v[172:175], v[20:23], v[236:239], 0
    s_waitcnt lgkmcnt(8)
    v_mfma_f32_16x16x32_bf16 v[188:191], v[24:27], v[236:239], 0
    s_barrier
    ds_read_b64_tr_b16 v[20:21], v90 offset:12288
    v_mfma_f32_16x16x32_bf16 v[184:187], v[24:27], v[232:235], 0
    ds_read_b64_tr_b16 v[22:23], v90 offset:13056
    v_mfma_f32_16x16x32_bf16 v[180:183], v[24:27], v[228:231], 0
    v_mfma_f32_16x16x32_bf16 v[176:179], v[24:27], v[224:227], 0
    s_waitcnt lgkmcnt(6)
    v_mfma_f32_16x16x32_bf16 v[192:195], v[12:15], v[224:227], 0
    ds_read_b64_tr_b16 v[24:25], v90 offset:15360
    v_mfma_f32_16x16x32_bf16 v[196:199], v[12:15], v[228:231], 0
    ds_read_b64_tr_b16 v[26:27], v90 offset:16128
    v_mfma_f32_16x16x32_bf16 v[200:203], v[12:15], v[232:235], 0
    v_mfma_f32_16x16x32_bf16 v[204:207], v[12:15], v[236:239], 0
    s_waitcnt lgkmcnt(4)
    v_mfma_f32_16x16x32_bf16 v[220:223], v[16:19], v[236:239], 0
    ds_read_b64_tr_b16 v[12:13], v91 offset:12288
    v_mfma_f32_16x16x32_bf16 v[216:219], v[16:19], v[232:235], 0
    ds_read_b64_tr_b16 v[14:15], v91 offset:13056
    v_mfma_f32_16x16x32_bf16 v[212:215], v[16:19], v[228:231], 0
    v_mfma_f32_16x16x32_bf16 v[208:211], v[16:19], v[224:227], 0
    s_waitcnt lgkmcnt(4)
    v_mfma_f32_16x16x32_bf16 v[128:131], v[20:23], v[240:243], v[128:131]
    ds_read_b64_tr_b16 v[16:17], v91 offset:15360
    v_mfma_f32_16x16x32_bf16 v[132:135], v[20:23], v[244:247], v[132:135]
    ds_read_b64_tr_b16 v[18:19], v91 offset:16128
    v_mfma_f32_16x16x32_bf16 v[136:139], v[20:23], v[248:251], v[136:139]
    v_mfma_f32_16x16x32_bf16 v[140:143], v[20:23], v[252:255], v[140:143]
    s_waitcnt lgkmcnt(4)
    v_mfma_f32_16x16x32_bf16 v[156:159], v[24:27], v[252:255], v[156:159]
    ds_read_b64_tr_b16 v[20:21], v92 offset:12288
    v_mfma_f32_16x16x32_bf16 v[152:155], v[24:27], v[248:251], v[152:155]
    ds_read_b64_tr_b16 v[22:23], v92 offset:13056
    v_mfma_f32_16x16x32_bf16 v[148:151], v[24:27], v[244:247], v[148:151]
    v_mfma_f32_16x16x32_bf16 v[144:147], v[24:27], v[240:243], v[144:147]
    s_waitcnt lgkmcnt(4)
    v_mfma_f32_16x16x32_bf16 v[160:163], v[12:15], v[240:243], v[160:163]
    ds_read_b64_tr_b16 v[24:25], v92 offset:15360
    v_mfma_f32_16x16x32_bf16 v[164:167], v[12:15], v[244:247], v[164:167]
    ds_read_b64_tr_b16 v[26:27], v92 offset:16128
    v_mfma_f32_16x16x32_bf16 v[168:171], v[12:15], v[248:251], v[168:171]
    v_mfma_f32_16x16x32_bf16 v[172:175], v[12:15], v[252:255], v[172:175]
    s_waitcnt lgkmcnt(4)
    v_mfma_f32_16x16x32_bf16 v[188:191], v[16:19], v[252:255], v[188:191]
    s_barrier
    ds_read_b128 v[224:227], v88 offset:16384
    v_mfma_f32_16x16x32_bf16 v[184:187], v[16:19], v[248:251], v[184:187]
    ds_read_b64_tr_b16 v[12:13], v90 offset:24576
    v_mfma_f32_16x16x32_bf16 v[180:183], v[16:19], v[244:247], v[180:183]
    ds_read_b64_tr_b16 v[14:15], v90 offset:25344
    v_mfma_f32_16x16x32_bf16 v[176:179], v[16:19], v[240:243], v[176:179]
    ds_read_b128 v[228:231], v88 offset:18432
    s_waitcnt lgkmcnt(6)
    v_mfma_f32_16x16x32_bf16 v[192:195], v[20:23], v[240:243], v[192:195]
    ds_read_b128 v[232:235], v88 offset:20480
    v_mfma_f32_16x16x32_bf16 v[196:199], v[20:23], v[244:247], v[196:199]
    ds_read_b128 v[236:239], v88 offset:22528
    v_mfma_f32_16x16x32_bf16 v[200:203], v[20:23], v[248:251], v[200:203]
    ds_read_b64_tr_b16 v[16:17], v90 offset:27648
    v_mfma_f32_16x16x32_bf16 v[204:207], v[20:23], v[252:255], v[204:207]
    ds_read_b64_tr_b16 v[18:19], v90 offset:28416
    s_waitcnt lgkmcnt(8)
    v_mfma_f32_16x16x32_bf16 v[220:223], v[24:27], v[252:255], v[220:223]
    ds_read_b64_tr_b16 v[20:21], v91 offset:24576
    v_mfma_f32_16x16x32_bf16 v[216:219], v[24:27], v[248:251], v[216:219]
    ds_read_b64_tr_b16 v[22:23], v91 offset:25344
    v_mfma_f32_16x16x32_bf16 v[212:215], v[24:27], v[244:247], v[212:215]
    v_mfma_f32_16x16x32_bf16 v[208:211], v[24:27], v[240:243], v[208:211]
    s_waitcnt lgkmcnt(4)
    v_mfma_f32_16x16x32_bf16 v[128:131], v[12:15], v[224:227], v[128:131]
    ds_read_b64_tr_b16 v[24:25], v91 offset:27648
    v_mfma_f32_16x16x32_bf16 v[132:135], v[12:15], v[228:231], v[132:135]
    ds_read_b64_tr_b16 v[26:27], v91 offset:28416
    v_mfma_f32_16x16x32_bf16 v[136:139], v[12:15], v[232:235], v[136:139]
    ds_read_b128 v[240:243], v89 offset:16384
    v_mfma_f32_16x16x32_bf16 v[140:143], v[12:15], v[236:239], v[140:143]
    ds_read_b128 v[244:247], v89 offset:18432
    s_waitcnt lgkmcnt(6)
    v_mfma_f32_16x16x32_bf16 v[156:159], v[16:19], v[236:239], v[156:159]
    ds_read_b64_tr_b16 v[12:13], v92 offset:24576
    v_mfma_f32_16x16x32_bf16 v[152:155], v[16:19], v[232:235], v[152:155]
    ds_read_b64_tr_b16 v[14:15], v92 offset:25344
    v_mfma_f32_16x16x32_bf16 v[148:151], v[16:19], v[228:231], v[148:151]
    ds_read_b128 v[248:251], v89 offset:20480
    v_mfma_f32_16x16x32_bf16 v[144:147], v[16:19], v[224:227], v[144:147]
    ds_read_b128 v[252:255], v89 offset:22528
    s_waitcnt lgkmcnt(8)
    v_mfma_f32_16x16x32_bf16 v[160:163], v[20:23], v[224:227], v[160:163]
    ds_read_b64_tr_b16 v[16:17], v92 offset:27648
    v_mfma_f32_16x16x32_bf16 v[164:167], v[20:23], v[228:231], v[164:167]
    ds_read_b64_tr_b16 v[18:19], v92 offset:28416
    v_mfma_f32_16x16x32_bf16 v[168:171], v[20:23], v[232:235], v[168:171]
    v_mfma_f32_16x16x32_bf16 v[172:175], v[20:23], v[236:239], v[172:175]
    s_waitcnt lgkmcnt(8)
    v_mfma_f32_16x16x32_bf16 v[188:191], v[24:27], v[236:239], v[188:191]
    s_barrier
    ds_read_b64_tr_b16 v[20:21], v90 offset:36864
    v_mfma_f32_16x16x32_bf16 v[184:187], v[24:27], v[232:235], v[184:187]
    ds_read_b64_tr_b16 v[22:23], v90 offset:37632
    v_mfma_f32_16x16x32_bf16 v[180:183], v[24:27], v[228:231], v[180:183]
    v_mfma_f32_16x16x32_bf16 v[176:179], v[24:27], v[224:227], v[176:179]
    s_waitcnt lgkmcnt(6)
    v_mfma_f32_16x16x32_bf16 v[192:195], v[12:15], v[224:227], v[192:195]
    ds_read_b64_tr_b16 v[24:25], v90 offset:39936
    v_mfma_f32_16x16x32_bf16 v[196:199], v[12:15], v[228:231], v[196:199]
    ds_read_b64_tr_b16 v[26:27], v90 offset:40704
    v_mfma_f32_16x16x32_bf16 v[200:203], v[12:15], v[232:235], v[200:203]
    v_mfma_f32_16x16x32_bf16 v[204:207], v[12:15], v[236:239], v[204:207]
    s_waitcnt lgkmcnt(4)
    v_mfma_f32_16x16x32_bf16 v[220:223], v[16:19], v[236:239], v[220:223]
    ds_read_b64_tr_b16 v[12:13], v91 offset:36864
    v_mfma_f32_16x16x32_bf16 v[216:219], v[16:19], v[232:235], v[216:219]
    ds_read_b64_tr_b16 v[14:15], v91 offset:37632
    v_mfma_f32_16x16x32_bf16 v[212:215], v[16:19], v[228:231], v[212:215]
    v_mfma_f32_16x16x32_bf16 v[208:211], v[16:19], v[224:227], v[208:211]
    s_waitcnt lgkmcnt(4)
    v_mfma_f32_16x16x32_bf16 v[128:131], v[20:23], v[240:243], v[128:131]
    ds_read_b64_tr_b16 v[16:17], v91 offset:39936
    v_mfma_f32_16x16x32_bf16 v[132:135], v[20:23], v[244:247], v[132:135]
    ds_read_b64_tr_b16 v[18:19], v91 offset:40704
    v_mfma_f32_16x16x32_bf16 v[136:139], v[20:23], v[248:251], v[136:139]
    v_mfma_f32_16x16x32_bf16 v[140:143], v[20:23], v[252:255], v[140:143]
    s_waitcnt lgkmcnt(4)
    v_mfma_f32_16x16x32_bf16 v[156:159], v[24:27], v[252:255], v[156:159]
    ds_read_b64_tr_b16 v[20:21], v92 offset:36864
    v_mfma_f32_16x16x32_bf16 v[152:155], v[24:27], v[248:251], v[152:155]
    ds_read_b64_tr_b16 v[22:23], v92 offset:37632
    v_mfma_f32_16x16x32_bf16 v[148:151], v[24:27], v[244:247], v[148:151]
    v_mfma_f32_16x16x32_bf16 v[144:147], v[24:27], v[240:243], v[144:147]
    s_waitcnt lgkmcnt(4)
    v_mfma_f32_16x16x32_bf16 v[160:163], v[12:15], v[240:243], v[160:163]
    ds_read_b64_tr_b16 v[24:25], v92 offset:39936
    v_mfma_f32_16x16x32_bf16 v[164:167], v[12:15], v[244:247], v[164:167]
    ds_read_b64_tr_b16 v[26:27], v92 offset:40704
    v_mfma_f32_16x16x32_bf16 v[168:171], v[12:15], v[248:251], v[168:171]
    v_mfma_f32_16x16x32_bf16 v[172:175], v[12:15], v[252:255], v[172:175]
    s_waitcnt lgkmcnt(4)
    v_mfma_f32_16x16x32_bf16 v[188:191], v[16:19], v[252:255], v[188:191]
    s_barrier
    ds_read_b128 v[224:227], v88 offset:32768
    v_mfma_f32_16x16x32_bf16 v[184:187], v[16:19], v[248:251], v[184:187]
    ds_read_b64_tr_b16 v[12:13], v90 offset:0
    v_mfma_f32_16x16x32_bf16 v[180:183], v[16:19], v[244:247], v[180:183]
    ds_read_b64_tr_b16 v[14:15], v90 offset:768
    v_mfma_f32_16x16x32_bf16 v[176:179], v[16:19], v[240:243], v[176:179]
    ds_read_b128 v[228:231], v88 offset:34816
    s_waitcnt lgkmcnt(6)
    v_mfma_f32_16x16x32_bf16 v[192:195], v[20:23], v[240:243], v[192:195]
    ds_read_b128 v[232:235], v88 offset:36864
    v_mfma_f32_16x16x32_bf16 v[196:199], v[20:23], v[244:247], v[196:199]
    ds_read_b128 v[236:239], v88 offset:38912
    v_mfma_f32_16x16x32_bf16 v[200:203], v[20:23], v[248:251], v[200:203]
    ds_read_b64_tr_b16 v[16:17], v90 offset:3072
    v_mfma_f32_16x16x32_bf16 v[204:207], v[20:23], v[252:255], v[204:207]
    ds_read_b64_tr_b16 v[18:19], v90 offset:3840
    s_waitcnt lgkmcnt(8)
    v_mfma_f32_16x16x32_bf16 v[220:223], v[24:27], v[252:255], v[220:223]
    ds_read_b64_tr_b16 v[20:21], v91 offset:0
    v_mfma_f32_16x16x32_bf16 v[216:219], v[24:27], v[248:251], v[216:219]
    ds_read_b64_tr_b16 v[22:23], v91 offset:768
    v_mfma_f32_16x16x32_bf16 v[212:215], v[24:27], v[244:247], v[212:215]
    v_mfma_f32_16x16x32_bf16 v[208:211], v[24:27], v[240:243], v[208:211]
    s_waitcnt lgkmcnt(4)
    v_mfma_f32_16x16x32_bf16 v[128:131], v[12:15], v[224:227], v[128:131]
    ds_read_b64_tr_b16 v[24:25], v91 offset:3072
    v_mfma_f32_16x16x32_bf16 v[132:135], v[12:15], v[228:231], v[132:135]
    ds_read_b64_tr_b16 v[26:27], v91 offset:3840
    v_mfma_f32_16x16x32_bf16 v[136:139], v[12:15], v[232:235], v[136:139]
    ds_read_b128 v[240:243], v89 offset:32768
    v_mfma_f32_16x16x32_bf16 v[140:143], v[12:15], v[236:239], v[140:143]
    ds_read_b128 v[244:247], v89 offset:34816
    s_waitcnt lgkmcnt(6)
    v_mfma_f32_16x16x32_bf16 v[156:159], v[16:19], v[236:239], v[156:159]
    ds_read_b64_tr_b16 v[12:13], v92 offset:0
    v_mfma_f32_16x16x32_bf16 v[152:155], v[16:19], v[232:235], v[152:155]
    ds_read_b64_tr_b16 v[14:15], v92 offset:768
    v_mfma_f32_16x16x32_bf16 v[148:151], v[16:19], v[228:231], v[148:151]
    ds_read_b128 v[248:251], v89 offset:36864
    v_mfma_f32_16x16x32_bf16 v[144:147], v[16:19], v[224:227], v[144:147]
    ds_read_b128 v[252:255], v89 offset:38912
    s_waitcnt lgkmcnt(8)
    v_mfma_f32_16x16x32_bf16 v[160:163], v[20:23], v[224:227], v[160:163]
    ds_read_b64_tr_b16 v[16:17], v92 offset:3072
    v_mfma_f32_16x16x32_bf16 v[164:167], v[20:23], v[228:231], v[164:167]
    ds_read_b64_tr_b16 v[18:19], v92 offset:3840
    v_mfma_f32_16x16x32_bf16 v[168:171], v[20:23], v[232:235], v[168:171]
    v_mfma_f32_16x16x32_bf16 v[172:175], v[20:23], v[236:239], v[172:175]
    s_waitcnt lgkmcnt(8)
    v_mfma_f32_16x16x32_bf16 v[188:191], v[24:27], v[236:239], v[188:191]
    s_barrier
    ds_read_b64_tr_b16 v[20:21], v90 offset:12288
    v_mfma_f32_16x16x32_bf16 v[184:187], v[24:27], v[232:235], v[184:187]
    ds_read_b64_tr_b16 v[22:23], v90 offset:13056
    v_mfma_f32_16x16x32_bf16 v[180:183], v[24:27], v[228:231], v[180:183]
    v_mfma_f32_16x16x32_bf16 v[176:179], v[24:27], v[224:227], v[176:179]
    s_waitcnt lgkmcnt(6)
    v_mfma_f32_16x16x32_bf16 v[192:195], v[12:15], v[224:227], v[192:195]
    ds_read_b64_tr_b16 v[24:25], v90 offset:15360
    v_mfma_f32_16x16x32_bf16 v[196:199], v[12:15], v[228:231], v[196:199]
    ds_read_b64_tr_b16 v[26:27], v90 offset:16128
    v_mfma_f32_16x16x32_bf16 v[200:203], v[12:15], v[232:235], v[200:203]
    v_mfma_f32_16x16x32_bf16 v[204:207], v[12:15], v[236:239], v[204:207]
    s_waitcnt lgkmcnt(4)
    v_mfma_f32_16x16x32_bf16 v[220:223], v[16:19], v[236:239], v[220:223]
    ds_read_b64_tr_b16 v[12:13], v91 offset:12288
    v_mfma_f32_16x16x32_bf16 v[216:219], v[16:19], v[232:235], v[216:219]
    ds_read_b64_tr_b16 v[14:15], v91 offset:13056
    v_mfma_f32_16x16x32_bf16 v[212:215], v[16:19], v[228:231], v[212:215]
    v_mfma_f32_16x16x32_bf16 v[208:211], v[16:19], v[224:227], v[208:211]
    s_waitcnt lgkmcnt(4)
    v_mfma_f32_16x16x32_bf16 v[128:131], v[20:23], v[240:243], v[128:131]
    ds_read_b64_tr_b16 v[16:17], v91 offset:15360
    v_mfma_f32_16x16x32_bf16 v[132:135], v[20:23], v[244:247], v[132:135]
    ds_read_b64_tr_b16 v[18:19], v91 offset:16128
    v_mfma_f32_16x16x32_bf16 v[136:139], v[20:23], v[248:251], v[136:139]
    v_mfma_f32_16x16x32_bf16 v[140:143], v[20:23], v[252:255], v[140:143]
    s_waitcnt lgkmcnt(4)
    v_mfma_f32_16x16x32_bf16 v[156:159], v[24:27], v[252:255], v[156:159]
    ds_read_b64_tr_b16 v[20:21], v92 offset:12288
    v_mfma_f32_16x16x32_bf16 v[152:155], v[24:27], v[248:251], v[152:155]
    ds_read_b64_tr_b16 v[22:23], v92 offset:13056
    v_mfma_f32_16x16x32_bf16 v[148:151], v[24:27], v[244:247], v[148:151]
    v_mfma_f32_16x16x32_bf16 v[144:147], v[24:27], v[240:243], v[144:147]
    s_waitcnt lgkmcnt(4)
    v_mfma_f32_16x16x32_bf16 v[160:163], v[12:15], v[240:243], v[160:163]
    ds_read_b64_tr_b16 v[24:25], v92 offset:15360
    v_mfma_f32_16x16x32_bf16 v[164:167], v[12:15], v[244:247], v[164:167]
    ds_read_b64_tr_b16 v[26:27], v92 offset:16128
    v_mfma_f32_16x16x32_bf16 v[168:171], v[12:15], v[248:251], v[168:171]
    v_mfma_f32_16x16x32_bf16 v[172:175], v[12:15], v[252:255], v[172:175]
    s_waitcnt lgkmcnt(4)
    v_mfma_f32_16x16x32_bf16 v[188:191], v[16:19], v[252:255], v[188:191]
    s_barrier
    ds_read_b128 v[224:227], v88 offset:0
    v_mfma_f32_16x16x32_bf16 v[184:187], v[16:19], v[248:251], v[184:187]
    ds_read_b64_tr_b16 v[12:13], v90 offset:24576
    v_mfma_f32_16x16x32_bf16 v[180:183], v[16:19], v[244:247], v[180:183]
    ds_read_b64_tr_b16 v[14:15], v90 offset:25344
    v_mfma_f32_16x16x32_bf16 v[176:179], v[16:19], v[240:243], v[176:179]
    ds_read_b128 v[228:231], v88 offset:2048
    s_waitcnt lgkmcnt(6)
    v_mfma_f32_16x16x32_bf16 v[192:195], v[20:23], v[240:243], v[192:195]
    ds_read_b128 v[232:235], v88 offset:4096
    v_mfma_f32_16x16x32_bf16 v[196:199], v[20:23], v[244:247], v[196:199]
    ds_read_b128 v[236:239], v88 offset:6144
    v_mfma_f32_16x16x32_bf16 v[200:203], v[20:23], v[248:251], v[200:203]
    ds_read_b64_tr_b16 v[16:17], v90 offset:27648
    v_mfma_f32_16x16x32_bf16 v[204:207], v[20:23], v[252:255], v[204:207]
    ds_read_b64_tr_b16 v[18:19], v90 offset:28416
    s_waitcnt lgkmcnt(8)
    v_mfma_f32_16x16x32_bf16 v[220:223], v[24:27], v[252:255], v[220:223]
    ds_read_b64_tr_b16 v[20:21], v91 offset:24576
    v_mfma_f32_16x16x32_bf16 v[216:219], v[24:27], v[248:251], v[216:219]
    ds_read_b64_tr_b16 v[22:23], v91 offset:25344
    v_mfma_f32_16x16x32_bf16 v[212:215], v[24:27], v[244:247], v[212:215]
    v_mfma_f32_16x16x32_bf16 v[208:211], v[24:27], v[240:243], v[208:211]
    s_waitcnt lgkmcnt(4)
    v_mfma_f32_16x16x32_bf16 v[128:131], v[12:15], v[224:227], v[128:131]
    ds_read_b64_tr_b16 v[24:25], v91 offset:27648
    v_mfma_f32_16x16x32_bf16 v[132:135], v[12:15], v[228:231], v[132:135]
    ds_read_b64_tr_b16 v[26:27], v91 offset:28416
    v_mfma_f32_16x16x32_bf16 v[136:139], v[12:15], v[232:235], v[136:139]
    ds_read_b128 v[240:243], v89 offset:0
    v_mfma_f32_16x16x32_bf16 v[140:143], v[12:15], v[236:239], v[140:143]
    ds_read_b128 v[244:247], v89 offset:2048
    s_waitcnt lgkmcnt(6)
    v_mfma_f32_16x16x32_bf16 v[156:159], v[16:19], v[236:239], v[156:159]
    ds_read_b64_tr_b16 v[12:13], v92 offset:24576
    v_mfma_f32_16x16x32_bf16 v[152:155], v[16:19], v[232:235], v[152:155]
    ds_read_b64_tr_b16 v[14:15], v92 offset:25344
    v_mfma_f32_16x16x32_bf16 v[148:151], v[16:19], v[228:231], v[148:151]
    ds_read_b128 v[248:251], v89 offset:4096
    v_mfma_f32_16x16x32_bf16 v[144:147], v[16:19], v[224:227], v[144:147]
    ds_read_b128 v[252:255], v89 offset:6144
    s_waitcnt lgkmcnt(8)
    v_mfma_f32_16x16x32_bf16 v[160:163], v[20:23], v[224:227], v[160:163]
    ds_read_b64_tr_b16 v[16:17], v92 offset:27648
    v_mfma_f32_16x16x32_bf16 v[164:167], v[20:23], v[228:231], v[164:167]
    ds_read_b64_tr_b16 v[18:19], v92 offset:28416
    v_mfma_f32_16x16x32_bf16 v[168:171], v[20:23], v[232:235], v[168:171]
    v_mfma_f32_16x16x32_bf16 v[172:175], v[20:23], v[236:239], v[172:175]
    s_waitcnt lgkmcnt(8)
    v_mfma_f32_16x16x32_bf16 v[188:191], v[24:27], v[236:239], v[188:191]
    s_barrier
    ds_read_b64_tr_b16 v[20:21], v90 offset:36864
    v_mfma_f32_16x16x32_bf16 v[184:187], v[24:27], v[232:235], v[184:187]
    ds_read_b64_tr_b16 v[22:23], v90 offset:37632
    v_mfma_f32_16x16x32_bf16 v[180:183], v[24:27], v[228:231], v[180:183]
    v_mfma_f32_16x16x32_bf16 v[176:179], v[24:27], v[224:227], v[176:179]
    s_waitcnt lgkmcnt(6)
    v_mfma_f32_16x16x32_bf16 v[192:195], v[12:15], v[224:227], v[192:195]
    ds_read_b64_tr_b16 v[24:25], v90 offset:39936
    v_mfma_f32_16x16x32_bf16 v[196:199], v[12:15], v[228:231], v[196:199]
    ds_read_b64_tr_b16 v[26:27], v90 offset:40704
    v_mfma_f32_16x16x32_bf16 v[200:203], v[12:15], v[232:235], v[200:203]
    v_mfma_f32_16x16x32_bf16 v[204:207], v[12:15], v[236:239], v[204:207]
    s_waitcnt lgkmcnt(4)
    v_mfma_f32_16x16x32_bf16 v[220:223], v[16:19], v[236:239], v[220:223]
    ds_read_b64_tr_b16 v[12:13], v91 offset:36864
    v_mfma_f32_16x16x32_bf16 v[216:219], v[16:19], v[232:235], v[216:219]
    ds_read_b64_tr_b16 v[14:15], v91 offset:37632
    v_mfma_f32_16x16x32_bf16 v[212:215], v[16:19], v[228:231], v[212:215]
    v_mfma_f32_16x16x32_bf16 v[208:211], v[16:19], v[224:227], v[208:211]
    s_waitcnt lgkmcnt(4)
    v_mfma_f32_16x16x32_bf16 v[128:131], v[20:23], v[240:243], v[128:131]
    ds_read_b64_tr_b16 v[16:17], v91 offset:39936
    v_mfma_f32_16x16x32_bf16 v[132:135], v[20:23], v[244:247], v[132:135]
    ds_read_b64_tr_b16 v[18:19], v91 offset:40704
    v_mfma_f32_16x16x32_bf16 v[136:139], v[20:23], v[248:251], v[136:139]
    v_mfma_f32_16x16x32_bf16 v[140:143], v[20:23], v[252:255], v[140:143]
    s_waitcnt lgkmcnt(4)
    v_mfma_f32_16x16x32_bf16 v[156:159], v[24:27], v[252:255], v[156:159]
    ds_read_b64_tr_b16 v[20:21], v92 offset:36864
    v_mfma_f32_16x16x32_bf16 v[152:155], v[24:27], v[248:251], v[152:155]
    ds_read_b64_tr_b16 v[22:23], v92 offset:37632
    v_mfma_f32_16x16x32_bf16 v[148:151], v[24:27], v[244:247], v[148:151]
    v_mfma_f32_16x16x32_bf16 v[144:147], v[24:27], v[240:243], v[144:147]
    s_waitcnt lgkmcnt(4)
    v_mfma_f32_16x16x32_bf16 v[160:163], v[12:15], v[240:243], v[160:163]
    ds_read_b64_tr_b16 v[24:25], v92 offset:39936
    v_mfma_f32_16x16x32_bf16 v[164:167], v[12:15], v[244:247], v[164:167]
    ds_read_b64_tr_b16 v[26:27], v92 offset:40704
    v_mfma_f32_16x16x32_bf16 v[168:171], v[12:15], v[248:251], v[168:171]
    v_mfma_f32_16x16x32_bf16 v[172:175], v[12:15], v[252:255], v[172:175]
    s_waitcnt lgkmcnt(4)
    v_mfma_f32_16x16x32_bf16 v[188:191], v[16:19], v[252:255], v[188:191]
    s_barrier
    ds_read_b128 v[224:227], v88 offset:16384
    v_mfma_f32_16x16x32_bf16 v[184:187], v[16:19], v[248:251], v[184:187]
    ds_read_b64_tr_b16 v[12:13], v90 offset:0
    v_mfma_f32_16x16x32_bf16 v[180:183], v[16:19], v[244:247], v[180:183]
    ds_read_b64_tr_b16 v[14:15], v90 offset:768
    v_mfma_f32_16x16x32_bf16 v[176:179], v[16:19], v[240:243], v[176:179]
    ds_read_b128 v[228:231], v88 offset:18432
    s_waitcnt lgkmcnt(6)
    v_mfma_f32_16x16x32_bf16 v[192:195], v[20:23], v[240:243], v[192:195]
    ds_read_b128 v[232:235], v88 offset:20480
    v_mfma_f32_16x16x32_bf16 v[196:199], v[20:23], v[244:247], v[196:199]
    ds_read_b128 v[236:239], v88 offset:22528
    v_mfma_f32_16x16x32_bf16 v[200:203], v[20:23], v[248:251], v[200:203]
    ds_read_b64_tr_b16 v[16:17], v90 offset:3072
    v_mfma_f32_16x16x32_bf16 v[204:207], v[20:23], v[252:255], v[204:207]
    ds_read_b64_tr_b16 v[18:19], v90 offset:3840
    s_waitcnt lgkmcnt(8)
    v_mfma_f32_16x16x32_bf16 v[220:223], v[24:27], v[252:255], v[220:223]
    ds_read_b64_tr_b16 v[20:21], v91 offset:0
    v_mfma_f32_16x16x32_bf16 v[216:219], v[24:27], v[248:251], v[216:219]
    ds_read_b64_tr_b16 v[22:23], v91 offset:768
    v_mfma_f32_16x16x32_bf16 v[212:215], v[24:27], v[244:247], v[212:215]
    v_mfma_f32_16x16x32_bf16 v[208:211], v[24:27], v[240:243], v[208:211]
    s_waitcnt lgkmcnt(4)
    v_mfma_f32_16x16x32_bf16 v[128:131], v[12:15], v[224:227], v[128:131]
    ds_read_b64_tr_b16 v[24:25], v91 offset:3072
    v_mfma_f32_16x16x32_bf16 v[132:135], v[12:15], v[228:231], v[132:135]
    ds_read_b64_tr_b16 v[26:27], v91 offset:3840
    v_mfma_f32_16x16x32_bf16 v[136:139], v[12:15], v[232:235], v[136:139]
    ds_read_b128 v[240:243], v89 offset:16384
    v_mfma_f32_16x16x32_bf16 v[140:143], v[12:15], v[236:239], v[140:143]
    ds_read_b128 v[244:247], v89 offset:18432
    s_waitcnt lgkmcnt(6)
    v_mfma_f32_16x16x32_bf16 v[156:159], v[16:19], v[236:239], v[156:159]
    ds_read_b64_tr_b16 v[12:13], v92 offset:0
    v_mfma_f32_16x16x32_bf16 v[152:155], v[16:19], v[232:235], v[152:155]
    ds_read_b64_tr_b16 v[14:15], v92 offset:768
    v_mfma_f32_16x16x32_bf16 v[148:151], v[16:19], v[228:231], v[148:151]
    ds_read_b128 v[248:251], v89 offset:20480
    v_mfma_f32_16x16x32_bf16 v[144:147], v[16:19], v[224:227], v[144:147]
    ds_read_b128 v[252:255], v89 offset:22528
    s_waitcnt lgkmcnt(8)
    v_mfma_f32_16x16x32_bf16 v[160:163], v[20:23], v[224:227], v[160:163]
    ds_read_b64_tr_b16 v[16:17], v92 offset:3072
    v_mfma_f32_16x16x32_bf16 v[164:167], v[20:23], v[228:231], v[164:167]
    ds_read_b64_tr_b16 v[18:19], v92 offset:3840
    v_mfma_f32_16x16x32_bf16 v[168:171], v[20:23], v[232:235], v[168:171]
    v_mfma_f32_16x16x32_bf16 v[172:175], v[20:23], v[236:239], v[172:175]
    s_waitcnt lgkmcnt(8)
    v_mfma_f32_16x16x32_bf16 v[188:191], v[24:27], v[236:239], v[188:191]
    s_barrier
    ds_read_b64_tr_b16 v[20:21], v90 offset:12288
    v_mfma_f32_16x16x32_bf16 v[184:187], v[24:27], v[232:235], v[184:187]
    ds_read_b64_tr_b16 v[22:23], v90 offset:13056
    v_mfma_f32_16x16x32_bf16 v[180:183], v[24:27], v[228:231], v[180:183]
    v_mfma_f32_16x16x32_bf16 v[176:179], v[24:27], v[224:227], v[176:179]
    s_waitcnt lgkmcnt(6)
    v_mfma_f32_16x16x32_bf16 v[192:195], v[12:15], v[224:227], v[192:195]
    ds_read_b64_tr_b16 v[24:25], v90 offset:15360
    v_mfma_f32_16x16x32_bf16 v[196:199], v[12:15], v[228:231], v[196:199]
    ds_read_b64_tr_b16 v[26:27], v90 offset:16128
    v_mfma_f32_16x16x32_bf16 v[200:203], v[12:15], v[232:235], v[200:203]
    v_mfma_f32_16x16x32_bf16 v[204:207], v[12:15], v[236:239], v[204:207]
    s_waitcnt lgkmcnt(4)
    v_mfma_f32_16x16x32_bf16 v[220:223], v[16:19], v[236:239], v[220:223]
    ds_read_b64_tr_b16 v[12:13], v91 offset:12288
    v_mfma_f32_16x16x32_bf16 v[216:219], v[16:19], v[232:235], v[216:219]
    ds_read_b64_tr_b16 v[14:15], v91 offset:13056
    v_mfma_f32_16x16x32_bf16 v[212:215], v[16:19], v[228:231], v[212:215]
    v_mfma_f32_16x16x32_bf16 v[208:211], v[16:19], v[224:227], v[208:211]
    s_waitcnt lgkmcnt(4)
    v_mfma_f32_16x16x32_bf16 v[128:131], v[20:23], v[240:243], v[128:131]
    ds_read_b64_tr_b16 v[16:17], v91 offset:15360
    v_mfma_f32_16x16x32_bf16 v[132:135], v[20:23], v[244:247], v[132:135]
    ds_read_b64_tr_b16 v[18:19], v91 offset:16128
    v_mfma_f32_16x16x32_bf16 v[136:139], v[20:23], v[248:251], v[136:139]
    v_mfma_f32_16x16x32_bf16 v[140:143], v[20:23], v[252:255], v[140:143]
    s_waitcnt lgkmcnt(4)
    v_mfma_f32_16x16x32_bf16 v[156:159], v[24:27], v[252:255], v[156:159]
    ds_read_b64_tr_b16 v[20:21], v92 offset:12288
    v_mfma_f32_16x16x32_bf16 v[152:155], v[24:27], v[248:251], v[152:155]
    ds_read_b64_tr_b16 v[22:23], v92 offset:13056
    v_mfma_f32_16x16x32_bf16 v[148:151], v[24:27], v[244:247], v[148:151]
    v_mfma_f32_16x16x32_bf16 v[144:147], v[24:27], v[240:243], v[144:147]
    s_waitcnt lgkmcnt(4)
    v_mfma_f32_16x16x32_bf16 v[160:163], v[12:15], v[240:243], v[160:163]
    ds_read_b64_tr_b16 v[24:25], v92 offset:15360
    v_mfma_f32_16x16x32_bf16 v[164:167], v[12:15], v[244:247], v[164:167]
    ds_read_b64_tr_b16 v[26:27], v92 offset:16128
    v_mfma_f32_16x16x32_bf16 v[168:171], v[12:15], v[248:251], v[168:171]
    v_mfma_f32_16x16x32_bf16 v[172:175], v[12:15], v[252:255], v[172:175]
    s_waitcnt lgkmcnt(4)
    v_mfma_f32_16x16x32_bf16 v[188:191], v[16:19], v[252:255], v[188:191]
    s_barrier
    ds_read_b128 v[224:227], v88 offset:32768
    v_mfma_f32_16x16x32_bf16 v[184:187], v[16:19], v[248:251], v[184:187]
    ds_read_b64_tr_b16 v[12:13], v90 offset:24576
    v_mfma_f32_16x16x32_bf16 v[180:183], v[16:19], v[244:247], v[180:183]
    ds_read_b64_tr_b16 v[14:15], v90 offset:25344
    v_mfma_f32_16x16x32_bf16 v[176:179], v[16:19], v[240:243], v[176:179]
    ds_read_b128 v[228:231], v88 offset:34816
    s_waitcnt lgkmcnt(6)
    v_mfma_f32_16x16x32_bf16 v[192:195], v[20:23], v[240:243], v[192:195]
    ds_read_b128 v[232:235], v88 offset:36864
    v_mfma_f32_16x16x32_bf16 v[196:199], v[20:23], v[244:247], v[196:199]
    ds_read_b128 v[236:239], v88 offset:38912
    v_mfma_f32_16x16x32_bf16 v[200:203], v[20:23], v[248:251], v[200:203]
    ds_read_b64_tr_b16 v[16:17], v90 offset:27648
    v_mfma_f32_16x16x32_bf16 v[204:207], v[20:23], v[252:255], v[204:207]
    ds_read_b64_tr_b16 v[18:19], v90 offset:28416
    s_waitcnt lgkmcnt(8)
    v_mfma_f32_16x16x32_bf16 v[220:223], v[24:27], v[252:255], v[220:223]
    ds_read_b64_tr_b16 v[20:21], v91 offset:24576
    v_mfma_f32_16x16x32_bf16 v[216:219], v[24:27], v[248:251], v[216:219]
    ds_read_b64_tr_b16 v[22:23], v91 offset:25344
    v_mfma_f32_16x16x32_bf16 v[212:215], v[24:27], v[244:247], v[212:215]
    v_mfma_f32_16x16x32_bf16 v[208:211], v[24:27], v[240:243], v[208:211]
    s_waitcnt lgkmcnt(4)
    v_mfma_f32_16x16x32_bf16 v[128:131], v[12:15], v[224:227], v[128:131]
    ds_read_b64_tr_b16 v[24:25], v91 offset:27648
    v_mfma_f32_16x16x32_bf16 v[132:135], v[12:15], v[228:231], v[132:135]
    ds_read_b64_tr_b16 v[26:27], v91 offset:28416
    v_mfma_f32_16x16x32_bf16 v[136:139], v[12:15], v[232:235], v[136:139]
    ds_read_b128 v[240:243], v89 offset:32768
    v_mfma_f32_16x16x32_bf16 v[140:143], v[12:15], v[236:239], v[140:143]
    ds_read_b128 v[244:247], v89 offset:34816
    s_waitcnt lgkmcnt(6)
    v_mfma_f32_16x16x32_bf16 v[156:159], v[16:19], v[236:239], v[156:159]
    ds_read_b64_tr_b16 v[12:13], v92 offset:24576
    v_mfma_f32_16x16x32_bf16 v[152:155], v[16:19], v[232:235], v[152:155]
    ds_read_b64_tr_b16 v[14:15], v92 offset:25344
    v_mfma_f32_16x16x32_bf16 v[148:151], v[16:19], v[228:231], v[148:151]
    ds_read_b128 v[248:251], v89 offset:36864
    v_mfma_f32_16x16x32_bf16 v[144:147], v[16:19], v[224:227], v[144:147]
    ds_read_b128 v[252:255], v89 offset:38912
    s_waitcnt lgkmcnt(8)
    v_mfma_f32_16x16x32_bf16 v[160:163], v[20:23], v[224:227], v[160:163]
    ds_read_b64_tr_b16 v[16:17], v92 offset:27648
    v_mfma_f32_16x16x32_bf16 v[164:167], v[20:23], v[228:231], v[164:167]
    ds_read_b64_tr_b16 v[18:19], v92 offset:28416
    v_mfma_f32_16x16x32_bf16 v[168:171], v[20:23], v[232:235], v[168:171]
    v_mfma_f32_16x16x32_bf16 v[172:175], v[20:23], v[236:239], v[172:175]
    s_waitcnt lgkmcnt(8)
    v_mfma_f32_16x16x32_bf16 v[188:191], v[24:27], v[236:239], v[188:191]
    s_barrier
    ds_read_b64_tr_b16 v[20:21], v90 offset:36864
    v_mfma_f32_16x16x32_bf16 v[184:187], v[24:27], v[232:235], v[184:187]
    ds_read_b64_tr_b16 v[22:23], v90 offset:37632
    v_mfma_f32_16x16x32_bf16 v[180:183], v[24:27], v[228:231], v[180:183]
    v_mfma_f32_16x16x32_bf16 v[176:179], v[24:27], v[224:227], v[176:179]
    s_waitcnt lgkmcnt(6)
    v_mfma_f32_16x16x32_bf16 v[192:195], v[12:15], v[224:227], v[192:195]
    ds_read_b64_tr_b16 v[24:25], v90 offset:39936
    v_mfma_f32_16x16x32_bf16 v[196:199], v[12:15], v[228:231], v[196:199]
    ds_read_b64_tr_b16 v[26:27], v90 offset:40704
    v_mfma_f32_16x16x32_bf16 v[200:203], v[12:15], v[232:235], v[200:203]
    v_mfma_f32_16x16x32_bf16 v[204:207], v[12:15], v[236:239], v[204:207]
    s_waitcnt lgkmcnt(4)
    v_mfma_f32_16x16x32_bf16 v[220:223], v[16:19], v[236:239], v[220:223]
    ds_read_b64_tr_b16 v[12:13], v91 offset:36864
    v_mfma_f32_16x16x32_bf16 v[216:219], v[16:19], v[232:235], v[216:219]
    ds_read_b64_tr_b16 v[14:15], v91 offset:37632
    v_mfma_f32_16x16x32_bf16 v[212:215], v[16:19], v[228:231], v[212:215]
    v_mfma_f32_16x16x32_bf16 v[208:211], v[16:19], v[224:227], v[208:211]
    s_waitcnt lgkmcnt(4)
    v_mfma_f32_16x16x32_bf16 v[128:131], v[20:23], v[240:243], v[128:131]
    ds_read_b64_tr_b16 v[16:17], v91 offset:39936
    v_mfma_f32_16x16x32_bf16 v[132:135], v[20:23], v[244:247], v[132:135]
    ds_read_b64_tr_b16 v[18:19], v91 offset:40704
    v_mfma_f32_16x16x32_bf16 v[136:139], v[20:23], v[248:251], v[136:139]
    v_mfma_f32_16x16x32_bf16 v[140:143], v[20:23], v[252:255], v[140:143]
    s_waitcnt lgkmcnt(4)
    v_mfma_f32_16x16x32_bf16 v[156:159], v[24:27], v[252:255], v[156:159]
    ds_read_b64_tr_b16 v[20:21], v92 offset:36864
    v_mfma_f32_16x16x32_bf16 v[152:155], v[24:27], v[248:251], v[152:155]
    ds_read_b64_tr_b16 v[22:23], v92 offset:37632
    v_mfma_f32_16x16x32_bf16 v[148:151], v[24:27], v[244:247], v[148:151]
    v_mfma_f32_16x16x32_bf16 v[144:147], v[24:27], v[240:243], v[144:147]
    s_waitcnt lgkmcnt(4)
    v_mfma_f32_16x16x32_bf16 v[160:163], v[12:15], v[240:243], v[160:163]
    ds_read_b64_tr_b16 v[24:25], v92 offset:39936
    v_mfma_f32_16x16x32_bf16 v[164:167], v[12:15], v[244:247], v[164:167]
    ds_read_b64_tr_b16 v[26:27], v92 offset:40704
    v_mfma_f32_16x16x32_bf16 v[168:171], v[12:15], v[248:251], v[168:171]
    v_mfma_f32_16x16x32_bf16 v[172:175], v[12:15], v[252:255], v[172:175]
    s_waitcnt lgkmcnt(4)
    v_mfma_f32_16x16x32_bf16 v[188:191], v[16:19], v[252:255], v[188:191]
    s_barrier
    ds_read_b128 v[224:227], v88 offset:0
    v_mfma_f32_16x16x32_bf16 v[184:187], v[16:19], v[248:251], v[184:187]
    ds_read_b64_tr_b16 v[12:13], v90 offset:0
    v_mfma_f32_16x16x32_bf16 v[180:183], v[16:19], v[244:247], v[180:183]
    ds_read_b64_tr_b16 v[14:15], v90 offset:768
    v_mfma_f32_16x16x32_bf16 v[176:179], v[16:19], v[240:243], v[176:179]
    ds_read_b128 v[228:231], v88 offset:2048
    s_waitcnt lgkmcnt(6)
    v_mfma_f32_16x16x32_bf16 v[192:195], v[20:23], v[240:243], v[192:195]
    ds_read_b128 v[232:235], v88 offset:4096
    v_mfma_f32_16x16x32_bf16 v[196:199], v[20:23], v[244:247], v[196:199]
    ds_read_b128 v[236:239], v88 offset:6144
    v_mfma_f32_16x16x32_bf16 v[200:203], v[20:23], v[248:251], v[200:203]
    ds_read_b64_tr_b16 v[16:17], v90 offset:3072
    v_mfma_f32_16x16x32_bf16 v[204:207], v[20:23], v[252:255], v[204:207]
    ds_read_b64_tr_b16 v[18:19], v90 offset:3840
    s_waitcnt lgkmcnt(8)
    v_mfma_f32_16x16x32_bf16 v[220:223], v[24:27], v[252:255], v[220:223]
    ds_read_b64_tr_b16 v[20:21], v91 offset:0
    v_mfma_f32_16x16x32_bf16 v[216:219], v[24:27], v[248:251], v[216:219]
    ds_read_b64_tr_b16 v[22:23], v91 offset:768
    v_mfma_f32_16x16x32_bf16 v[212:215], v[24:27], v[244:247], v[212:215]
    v_mfma_f32_16x16x32_bf16 v[208:211], v[24:27], v[240:243], v[208:211]
    s_waitcnt lgkmcnt(4)
    v_mfma_f32_16x16x32_bf16 v[128:131], v[12:15], v[224:227], v[128:131]
    ds_read_b64_tr_b16 v[24:25], v91 offset:3072
    v_mfma_f32_16x16x32_bf16 v[132:135], v[12:15], v[228:231], v[132:135]
    ds_read_b64_tr_b16 v[26:27], v91 offset:3840
    v_mfma_f32_16x16x32_bf16 v[136:139], v[12:15], v[232:235], v[136:139]
    ds_read_b128 v[240:243], v89 offset:0
    v_mfma_f32_16x16x32_bf16 v[140:143], v[12:15], v[236:239], v[140:143]
    ds_read_b128 v[244:247], v89 offset:2048
    s_waitcnt lgkmcnt(6)
    v_mfma_f32_16x16x32_bf16 v[156:159], v[16:19], v[236:239], v[156:159]
    ds_read_b64_tr_b16 v[12:13], v92 offset:0
    v_mfma_f32_16x16x32_bf16 v[152:155], v[16:19], v[232:235], v[152:155]
    ds_read_b64_tr_b16 v[14:15], v92 offset:768
    v_mfma_f32_16x16x32_bf16 v[148:151], v[16:19], v[228:231], v[148:151]
    ds_read_b128 v[248:251], v89 offset:4096
    v_mfma_f32_16x16x32_bf16 v[144:147], v[16:19], v[224:227], v[144:147]
    ds_read_b128 v[252:255], v89 offset:6144
    s_waitcnt lgkmcnt(8)
    v_mfma_f32_16x16x32_bf16 v[160:163], v[20:23], v[224:227], v[160:163]
    ds_read_b64_tr_b16 v[16:17], v92 offset:3072
    v_mfma_f32_16x16x32_bf16 v[164:167], v[20:23], v[228:231], v[164:167]
    ds_read_b64_tr_b16 v[18:19], v92 offset:3840
    v_mfma_f32_16x16x32_bf16 v[168:171], v[20:23], v[232:235], v[168:171]
    v_mfma_f32_16x16x32_bf16 v[172:175], v[20:23], v[236:239], v[172:175]
    s_waitcnt lgkmcnt(8)
    v_mfma_f32_16x16x32_bf16 v[188:191], v[24:27], v[236:239], v[188:191]
    s_barrier
    ds_read_b64_tr_b16 v[20:21], v90 offset:12288
    v_mfma_f32_16x16x32_bf16 v[184:187], v[24:27], v[232:235], v[184:187]
    ds_read_b64_tr_b16 v[22:23], v90 offset:13056
    v_mfma_f32_16x16x32_bf16 v[180:183], v[24:27], v[228:231], v[180:183]
    v_mfma_f32_16x16x32_bf16 v[176:179], v[24:27], v[224:227], v[176:179]
    s_waitcnt lgkmcnt(6)
    v_mfma_f32_16x16x32_bf16 v[192:195], v[12:15], v[224:227], v[192:195]
    ds_read_b64_tr_b16 v[24:25], v90 offset:15360
    v_mfma_f32_16x16x32_bf16 v[196:199], v[12:15], v[228:231], v[196:199]
    ds_read_b64_tr_b16 v[26:27], v90 offset:16128
    v_mfma_f32_16x16x32_bf16 v[200:203], v[12:15], v[232:235], v[200:203]
    v_mfma_f32_16x16x32_bf16 v[204:207], v[12:15], v[236:239], v[204:207]
    s_waitcnt lgkmcnt(4)
    v_mfma_f32_16x16x32_bf16 v[220:223], v[16:19], v[236:239], v[220:223]
    ds_read_b64_tr_b16 v[12:13], v91 offset:12288
    v_mfma_f32_16x16x32_bf16 v[216:219], v[16:19], v[232:235], v[216:219]
    ds_read_b64_tr_b16 v[14:15], v91 offset:13056
    v_mfma_f32_16x16x32_bf16 v[212:215], v[16:19], v[228:231], v[212:215]
    v_mfma_f32_16x16x32_bf16 v[208:211], v[16:19], v[224:227], v[208:211]
    s_waitcnt lgkmcnt(4)
    v_mfma_f32_16x16x32_bf16 v[128:131], v[20:23], v[240:243], v[128:131]
    ds_read_b64_tr_b16 v[16:17], v91 offset:15360
    v_mfma_f32_16x16x32_bf16 v[132:135], v[20:23], v[244:247], v[132:135]
    ds_read_b64_tr_b16 v[18:19], v91 offset:16128
    v_mfma_f32_16x16x32_bf16 v[136:139], v[20:23], v[248:251], v[136:139]
    v_mfma_f32_16x16x32_bf16 v[140:143], v[20:23], v[252:255], v[140:143]
    s_waitcnt lgkmcnt(4)
    v_mfma_f32_16x16x32_bf16 v[156:159], v[24:27], v[252:255], v[156:159]
    ds_read_b64_tr_b16 v[20:21], v92 offset:12288
    v_mfma_f32_16x16x32_bf16 v[152:155], v[24:27], v[248:251], v[152:155]
    ds_read_b64_tr_b16 v[22:23], v92 offset:13056
    v_mfma_f32_16x16x32_bf16 v[148:151], v[24:27], v[244:247], v[148:151]
    v_mfma_f32_16x16x32_bf16 v[144:147], v[24:27], v[240:243], v[144:147]
    s_waitcnt lgkmcnt(4)
    v_mfma_f32_16x16x32_bf16 v[160:163], v[12:15], v[240:243], v[160:163]
    ds_read_b64_tr_b16 v[24:25], v92 offset:15360
    v_mfma_f32_16x16x32_bf16 v[164:167], v[12:15], v[244:247], v[164:167]
    ds_read_b64_tr_b16 v[26:27], v92 offset:16128
    v_mfma_f32_16x16x32_bf16 v[168:171], v[12:15], v[248:251], v[168:171]
    v_mfma_f32_16x16x32_bf16 v[172:175], v[12:15], v[252:255], v[172:175]
    s_waitcnt lgkmcnt(4)
    v_mfma_f32_16x16x32_bf16 v[188:191], v[16:19], v[252:255], v[188:191]
    s_barrier
    ds_read_b128 v[224:227], v88 offset:16384
    v_mfma_f32_16x16x32_bf16 v[184:187], v[16:19], v[248:251], v[184:187]
    ds_read_b64_tr_b16 v[12:13], v90 offset:24576
    v_mfma_f32_16x16x32_bf16 v[180:183], v[16:19], v[244:247], v[180:183]
    ds_read_b64_tr_b16 v[14:15], v90 offset:25344
    v_mfma_f32_16x16x32_bf16 v[176:179], v[16:19], v[240:243], v[176:179]
    ds_read_b128 v[228:231], v88 offset:18432
    s_waitcnt lgkmcnt(6)
    v_mfma_f32_16x16x32_bf16 v[192:195], v[20:23], v[240:243], v[192:195]
    ds_read_b128 v[232:235], v88 offset:20480
    v_mfma_f32_16x16x32_bf16 v[196:199], v[20:23], v[244:247], v[196:199]
    ds_read_b128 v[236:239], v88 offset:22528
    v_mfma_f32_16x16x32_bf16 v[200:203], v[20:23], v[248:251], v[200:203]
    ds_read_b64_tr_b16 v[16:17], v90 offset:27648
    v_mfma_f32_16x16x32_bf16 v[204:207], v[20:23], v[252:255], v[204:207]
    ds_read_b64_tr_b16 v[18:19], v90 offset:28416
    s_waitcnt lgkmcnt(8)
    v_mfma_f32_16x16x32_bf16 v[220:223], v[24:27], v[252:255], v[220:223]
    ds_read_b64_tr_b16 v[20:21], v91 offset:24576
    v_mfma_f32_16x16x32_bf16 v[216:219], v[24:27], v[248:251], v[216:219]
    ds_read_b64_tr_b16 v[22:23], v91 offset:25344
    v_mfma_f32_16x16x32_bf16 v[212:215], v[24:27], v[244:247], v[212:215]
    v_mfma_f32_16x16x32_bf16 v[208:211], v[24:27], v[240:243], v[208:211]
    s_waitcnt lgkmcnt(4)
    v_mfma_f32_16x16x32_bf16 v[128:131], v[12:15], v[224:227], v[128:131]
    ds_read_b64_tr_b16 v[24:25], v91 offset:27648
    v_mfma_f32_16x16x32_bf16 v[132:135], v[12:15], v[228:231], v[132:135]
    ds_read_b64_tr_b16 v[26:27], v91 offset:28416
    v_mfma_f32_16x16x32_bf16 v[136:139], v[12:15], v[232:235], v[136:139]
    ds_read_b128 v[240:243], v89 offset:16384
    v_mfma_f32_16x16x32_bf16 v[140:143], v[12:15], v[236:239], v[140:143]
    ds_read_b128 v[244:247], v89 offset:18432
    s_waitcnt lgkmcnt(6)
    v_mfma_f32_16x16x32_bf16 v[156:159], v[16:19], v[236:239], v[156:159]
    ds_read_b64_tr_b16 v[12:13], v92 offset:24576
    v_mfma_f32_16x16x32_bf16 v[152:155], v[16:19], v[232:235], v[152:155]
    ds_read_b64_tr_b16 v[14:15], v92 offset:25344
    v_mfma_f32_16x16x32_bf16 v[148:151], v[16:19], v[228:231], v[148:151]
    ds_read_b128 v[248:251], v89 offset:20480
    v_mfma_f32_16x16x32_bf16 v[144:147], v[16:19], v[224:227], v[144:147]
    ds_read_b128 v[252:255], v89 offset:22528
    s_waitcnt lgkmcnt(8)
    v_mfma_f32_16x16x32_bf16 v[160:163], v[20:23], v[224:227], v[160:163]
    ds_read_b64_tr_b16 v[16:17], v92 offset:27648
    v_mfma_f32_16x16x32_bf16 v[164:167], v[20:23], v[228:231], v[164:167]
    ds_read_b64_tr_b16 v[18:19], v92 offset:28416
    v_mfma_f32_16x16x32_bf16 v[168:171], v[20:23], v[232:235], v[168:171]
    v_mfma_f32_16x16x32_bf16 v[172:175], v[20:23], v[236:239], v[172:175]
    s_waitcnt lgkmcnt(8)
    v_mfma_f32_16x16x32_bf16 v[188:191], v[24:27], v[236:239], v[188:191]
    s_barrier
    ds_read_b64_tr_b16 v[20:21], v90 offset:36864
    v_mfma_f32_16x16x32_bf16 v[184:187], v[24:27], v[232:235], v[184:187]
    ds_read_b64_tr_b16 v[22:23], v90 offset:37632
    v_mfma_f32_16x16x32_bf16 v[180:183], v[24:27], v[228:231], v[180:183]
    v_mfma_f32_16x16x32_bf16 v[176:179], v[24:27], v[224:227], v[176:179]
    s_waitcnt lgkmcnt(6)
    v_mfma_f32_16x16x32_bf16 v[192:195], v[12:15], v[224:227], v[192:195]
    ds_read_b64_tr_b16 v[24:25], v91 offset:36864
    v_mfma_f32_16x16x32_bf16 v[196:199], v[12:15], v[228:231], v[196:199]
    ds_read_b64_tr_b16 v[26:27], v91 offset:37632
    v_mfma_f32_16x16x32_bf16 v[200:203], v[12:15], v[232:235], v[200:203]
    v_mfma_f32_16x16x32_bf16 v[204:207], v[12:15], v[236:239], v[204:207]
    s_waitcnt lgkmcnt(4)
    v_mfma_f32_16x16x32_bf16 v[220:223], v[16:19], v[236:239], v[220:223]
    ds_read_b64_tr_b16 v[12:13], v92 offset:36864
    v_mfma_f32_16x16x32_bf16 v[216:219], v[16:19], v[232:235], v[216:219]
    ds_read_b64_tr_b16 v[14:15], v92 offset:37632
    v_mfma_f32_16x16x32_bf16 v[212:215], v[16:19], v[228:231], v[212:215]
    v_mfma_f32_16x16x32_bf16 v[208:211], v[16:19], v[224:227], v[208:211]
    s_waitcnt lgkmcnt(4)
    v_mfma_f32_16x16x32_bf16 v[128:131], v[20:23], v[240:243], v[128:131]
    ds_read_b64_tr_b16 v[16:17], v90 offset:39936
    v_mfma_f32_16x16x32_bf16 v[132:135], v[20:23], v[244:247], v[132:135]
    ds_read_b64_tr_b16 v[18:19], v90 offset:40704
    v_mfma_f32_16x16x32_bf16 v[136:139], v[20:23], v[248:251], v[136:139]
    v_mfma_f32_16x16x32_bf16 v[140:143], v[20:23], v[252:255], v[140:143]
    s_waitcnt lgkmcnt(4)
    v_mfma_f32_16x16x32_bf16 v[172:175], v[24:27], v[252:255], v[172:175]
    ds_read_b64_tr_b16 v[20:21], v91 offset:39936
    v_mfma_f32_16x16x32_bf16 v[168:171], v[24:27], v[248:251], v[168:171]
    ds_read_b64_tr_b16 v[22:23], v91 offset:40704
    v_mfma_f32_16x16x32_bf16 v[164:167], v[24:27], v[244:247], v[164:167]
    v_mul_f32 v224, s52, v128
    v_mul_f32 v225, s52, v129
    v_mfma_f32_16x16x32_bf16 v[160:163], v[24:27], v[240:243], v[160:163]
    v_mul_f32 v226, s52, v130
    v_mul_f32 v227, s52, v131
    s_waitcnt lgkmcnt(4)
    v_mfma_f32_16x16x32_bf16 v[192:195], v[12:15], v[240:243], v[192:195]
    ds_read_b64_tr_b16 v[24:25], v92 offset:39936
    v_mfma_f32_16x16x32_bf16 v[196:199], v[12:15], v[244:247], v[196:199]
    ds_read_b64_tr_b16 v[26:27], v92 offset:40704
    v_mfma_f32_16x16x32_bf16 v[200:203], v[12:15], v[248:251], v[200:203]
    v_exp_f32 v224, v224
    v_mfma_f32_16x16x32_bf16 v[204:207], v[12:15], v[252:255], v[204:207]
    v_exp_f32 v225, v225
    s_waitcnt lgkmcnt(4)
    v_mfma_f32_16x16x32_bf16 v[156:159], v[16:19], v[252:255], v[156:159]
    v_exp_f32 v226, v226
    v_mfma_f32_16x16x32_bf16 v[152:155], v[16:19], v[248:251], v[152:155]
    v_exp_f32 v227, v227
    v_mfma_f32_16x16x32_bf16 v[148:151], v[16:19], v[244:247], v[148:151]
    v_mul_f32 v228, s52, v132
    v_mul_f32 v229, s52, v133
    v_mfma_f32_16x16x32_bf16 v[144:147], v[16:19], v[240:243], v[144:147]
    v_mul_f32 v230, s52, v134
    v_mul_f32 v231, s52, v135
    s_waitcnt lgkmcnt(2)
    v_mfma_f32_16x16x32_bf16 v[176:179], v[20:23], v[240:243], v[176:179]
    v_exp_f32 v228, v228
    v_mfma_f32_16x16x32_bf16 v[180:183], v[20:23], v[244:247], v[180:183]
    v_exp_f32 v229, v229
    v_mfma_f32_16x16x32_bf16 v[184:187], v[20:23], v[248:251], v[184:187]
    v_exp_f32 v230, v230
    v_mfma_f32_16x16x32_bf16 v[188:191], v[20:23], v[252:255], v[188:191]
    v_exp_f32 v231, v231
    s_waitcnt lgkmcnt(0)
    v_mfma_f32_16x16x32_bf16 v[220:223], v[24:27], v[252:255], v[220:223]
    v_mul_f32 v232, s52, v136
    v_mul_f32 v233, s52, v137
    v_mfma_f32_16x16x32_bf16 v[216:219], v[24:27], v[248:251], v[216:219]
    v_mul_f32 v234, s52, v138
    v_mul_f32 v235, s52, v139
    v_mfma_f32_16x16x32_bf16 v[212:215], v[24:27], v[244:247], v[212:215]
    v_exp_f32 v232, v232
    v_mfma_f32_16x16x32_bf16 v[208:211], v[24:27], v[240:243], v[208:211]
    v_exp_f32 v233, v233
    s_nop 0
    v_exp_f32 v234, v234
    v_exp_f32 v235, v235
    v_pk_mul_f32 v[236:237], v[140:141], s[52:53]
    v_pk_mul_f32 v[238:239], v[142:143], s[52:53]
    v_exp_f32 v236, v236
    v_exp_f32 v237, v237
    v_exp_f32 v238, v238
    v_exp_f32 v239, v239
    s_barrier
    ds_read_b128 v[96:99], v126 offset:32768
    ds_read_b128 v[100:103], v126 offset:33024
    v_mul_f32 v28, s52, v160
    v_mul_f32 v29, s52, v161
    v_mul_f32 v30, s52, v162
    v_mul_f32 v31, s52, v163
    v_exp_f32 v28, v28
    v_exp_f32 v29, v29
    v_exp_f32 v30, v30
    v_exp_f32 v31, v31
    v_mul_f32 v32, s52, v164
    v_mul_f32 v33, s52, v165
    v_mul_f32 v34, s52, v166
    v_mul_f32 v35, s52, v167
    v_exp_f32 v32, v32
    v_exp_f32 v33, v33
    v_exp_f32 v34, v34
    v_exp_f32 v35, v35
    v_mul_f32 v36, s52, v168
    v_mul_f32 v37, s52, v169
    v_mul_f32 v38, s52, v170
    v_mul_f32 v39, s52, v171
    v_exp_f32 v36, v36
    v_exp_f32 v37, v37
    v_exp_f32 v38, v38
    v_exp_f32 v39, v39
    v_mul_f32 v40, s52, v172
    v_mul_f32 v41, s52, v173
    v_mul_f32 v42, s52, v174
    v_mul_f32 v43, s52, v175
    v_exp_f32 v40, v40
    v_exp_f32 v41, v41
    v_exp_f32 v42, v42
    v_exp_f32 v43, v43
    v_mul_f32 v112, s52, v192
    v_mul_f32 v113, s52, v193
    v_mul_f32 v114, s52, v194
    v_mul_f32 v115, s52, v195
    v_exp_f32 v112, v112
    v_exp_f32 v113, v113
    v_exp_f32 v114, v114
    v_exp_f32 v115, v115
    v_mul_f32 v116, s52, v196
    v_mul_f32 v117, s52, v197
    v_mul_f32 v118, s52, v198
    v_mul_f32 v119, s52, v199
    v_exp_f32 v116, v116
    v_exp_f32 v117, v117
    v_exp_f32 v118, v118
    v_exp_f32 v119, v119
    v_mul_f32 v240, s52, v200
    v_mul_f32 v241, s52, v201
    v_mul_f32 v242, s52, v202
    v_mul_f32 v243, s52, v203
    v_exp_f32 v240, v240
    v_exp_f32 v241, v241
    v_exp_f32 v242, v242
    v_exp_f32 v243, v243
    v_mul_f32 v244, s52, v204
    v_mul_f32 v245, s52, v205
    v_mul_f32 v246, s52, v206
    v_mul_f32 v247, s52, v207
    v_exp_f32 v244, v244
    v_exp_f32 v245, v245
    v_exp_f32 v246, v246
    v_exp_f32 v247, v247
    s_waitcnt lgkmcnt(0)
    v_fma_f32 v224, v224, v96, v96
    v_fma_f32 v225, v225, v96, v96
    v_fma_f32 v226, v226, v96, v96
    v_fma_f32 v227, v227, v96, v96
    v_rcp_f32 v224, v224
    v_rcp_f32 v225, v225
    v_rcp_f32 v226, v226
    v_rcp_f32 v227, v227
    v_mul_f32 v224, v224, v128
    v_mul_f32 v225, v225, v129
    v_mul_f32 v226, v226, v130
    v_mul_f32 v227, v227, v131
    v_mul_f32 v224, v224, v144
    v_mul_f32 v225, v225, v145
    v_mul_f32 v226, v226, v146
    v_mul_f32 v227, v227, v147
    v_cvt_pk_bf16_f32 v128, v224, v225
    v_cvt_pk_bf16_f32 v129, v226, v227
    v_fma_f32 v228, v228, v98, v98
    v_fma_f32 v229, v229, v98, v98
    v_fma_f32 v230, v230, v98, v98
    v_fma_f32 v231, v231, v98, v98
    v_rcp_f32 v228, v228
    v_rcp_f32 v229, v229
    v_rcp_f32 v230, v230
    v_rcp_f32 v231, v231
    v_pk_mul_f32 v[228:229], v[228:229], v[132:133]
    v_pk_mul_f32 v[230:231], v[230:231], v[134:135]
    v_pk_mul_f32 v[228:229], v[228:229], v[148:149]
    v_pk_mul_f32 v[230:231], v[230:231], v[150:151]
    v_cvt_pk_bf16_f32 v130, v228, v229
    v_cvt_pk_bf16_f32 v131, v230, v231
    v_pk_fma_f32 v[232:233], v[232:233], v[100:101], v[100:101]
    v_pk_fma_f32 v[234:235], v[234:235], v[100:101], v[100:101]
    v_permlane16_swap_b32 v128, v130
    v_permlane16_swap_b32 v129, v131
    v_rcp_f32 v232, v232
    v_rcp_f32 v233, v233
    v_rcp_f32 v234, v234
    v_rcp_f32 v235, v235
    v_pk_mul_f32 v[232:233], v[232:233], v[136:137]
    v_pk_mul_f32 v[234:235], v[234:235], v[138:139]
    v_pk_mul_f32 v[232:233], v[232:233], v[152:153]
    v_pk_mul_f32 v[234:235], v[234:235], v[154:155]
    v_cvt_pk_bf16_f32 v136, v232, v233
    v_cvt_pk_bf16_f32 v137, v234, v235
    v_pk_fma_f32 v[236:237], v[236:237], v[102:103], v[102:103]
    v_pk_fma_f32 v[238:239], v[238:239], v[102:103], v[102:103]
    v_rcp_f32 v236, v236
    v_rcp_f32 v237, v237
    v_rcp_f32 v238, v238
    v_rcp_f32 v239, v239
    v_pk_mul_f32 v[236:237], v[236:237], v[140:141]
    v_pk_mul_f32 v[238:239], v[238:239], v[142:143]
    v_pk_mul_f32 v[236:237], v[236:237], v[156:157]
    v_pk_mul_f32 v[238:239], v[238:239], v[158:159]
    v_cvt_pk_bf16_f32 v138, v236, v237
    v_cvt_pk_bf16_f32 v139, v238, v239
    v_pk_fma_f32 v[28:29], v[28:29], v[96:97], v[96:97]
    v_pk_fma_f32 v[30:31], v[30:31], v[96:97], v[96:97]
    v_permlane16_swap_b32 v136, v138
    v_permlane16_swap_b32 v137, v139
    v_rcp_f32 v28, v28
    v_rcp_f32 v29, v29
    v_rcp_f32 v30, v30
    v_rcp_f32 v31, v31
    v_pk_mul_f32 v[28:29], v[28:29], v[160:161]
    v_pk_mul_f32 v[30:31], v[30:31], v[162:163]
    v_pk_mul_f32 v[28:29], v[28:29], v[176:177]
    v_pk_mul_f32 v[30:31], v[30:31], v[178:179]
    v_cvt_pk_bf16_f32 v160, v28, v29
    v_cvt_pk_bf16_f32 v161, v30, v31
    v_pk_fma_f32 v[32:33], v[32:33], v[98:99], v[98:99]
    v_pk_fma_f32 v[34:35], v[34:35], v[98:99], v[98:99]
    v_rcp_f32 v32, v32
    v_rcp_f32 v33, v33
    v_rcp_f32 v34, v34
    v_rcp_f32 v35, v35
    v_pk_mul_f32 v[32:33], v[32:33], v[164:165]
    v_pk_mul_f32 v[34:35], v[34:35], v[166:167]
    v_pk_mul_f32 v[32:33], v[32:33], v[180:181]
    v_pk_mul_f32 v[34:35], v[34:35], v[182:183]
    v_cvt_pk_bf16_f32 v162, v32, v33
    v_cvt_pk_bf16_f32 v163, v34, v35
    v_pk_fma_f32 v[36:37], v[36:37], v[100:101], v[100:101]
    v_pk_fma_f32 v[38:39], v[38:39], v[100:101], v[100:101]
    v_permlane16_swap_b32 v160, v162
    v_permlane16_swap_b32 v161, v163
    v_rcp_f32 v36, v36
    v_rcp_f32 v37, v37
    v_rcp_f32 v38, v38
    v_rcp_f32 v39, v39
    v_pk_mul_f32 v[36:37], v[36:37], v[168:169]
    v_pk_mul_f32 v[38:39], v[38:39], v[170:171]
    v_pk_mul_f32 v[36:37], v[36:37], v[184:185]
    v_pk_mul_f32 v[38:39], v[38:39], v[186:187]
    v_cvt_pk_bf16_f32 v168, v36, v37
    v_cvt_pk_bf16_f32 v169, v38, v39
    v_pk_fma_f32 v[40:41], v[40:41], v[102:103], v[102:103]
    v_pk_fma_f32 v[42:43], v[42:43], v[102:103], v[102:103]
    v_rcp_f32 v40, v40
    v_rcp_f32 v41, v41
    v_rcp_f32 v42, v42
    v_rcp_f32 v43, v43
    v_pk_mul_f32 v[40:41], v[40:41], v[172:173]
    buffer_store_dwordx4 v[128:131], v2, s[28:31], s65 offen offset:0 sc1
    v_pk_mul_f32 v[42:43], v[42:43], v[174:175]
    v_pk_mul_f32 v[40:41], v[40:41], v[188:189]
    v_pk_mul_f32 v[42:43], v[42:43], v[190:191]
    v_cvt_pk_bf16_f32 v170, v40, v41
    v_cvt_pk_bf16_f32 v171, v42, v43
    v_pk_fma_f32 v[112:113], v[112:113], v[96:97], v[96:97]
    v_pk_fma_f32 v[114:115], v[114:115], v[96:97], v[96:97]
    v_permlane16_swap_b32 v168, v170
    v_permlane16_swap_b32 v169, v171
    v_rcp_f32 v112, v112
    v_rcp_f32 v113, v113
    v_rcp_f32 v114, v114
    buffer_store_dwordx4 v[136:139], v2, s[28:31], s66 offen offset:0 sc1
    v_rcp_f32 v115, v115
    v_pk_mul_f32 v[112:113], v[112:113], v[192:193]
    v_pk_mul_f32 v[114:115], v[114:115], v[194:195]
    v_pk_mul_f32 v[112:113], v[112:113], v[208:209]
    v_pk_mul_f32 v[114:115], v[114:115], v[210:211]
    v_cvt_pk_bf16_f32 v192, v112, v113
    v_cvt_pk_bf16_f32 v193, v114, v115
    v_pk_fma_f32 v[116:117], v[116:117], v[98:99], v[98:99]
    v_pk_fma_f32 v[118:119], v[118:119], v[98:99], v[98:99]
    v_rcp_f32 v116, v116
    v_rcp_f32 v117, v117
    v_rcp_f32 v118, v118
    buffer_store_dwordx4 v[160:163], v2, s[28:31], s65 offen offset:1024 sc1
    v_rcp_f32 v119, v119
    v_pk_mul_f32 v[116:117], v[116:117], v[196:197]
    v_pk_mul_f32 v[118:119], v[118:119], v[198:199]
    v_pk_mul_f32 v[116:117], v[116:117], v[212:213]
    v_pk_mul_f32 v[118:119], v[118:119], v[214:215]
    v_cvt_pk_bf16_f32 v194, v116, v117
    v_cvt_pk_bf16_f32 v195, v118, v119
    v_pk_fma_f32 v[240:241], v[240:241], v[100:101], v[100:101]
    v_pk_fma_f32 v[242:243], v[242:243], v[100:101], v[100:101]
    v_permlane16_swap_b32 v192, v194
    v_permlane16_swap_b32 v193, v195
    v_rcp_f32 v240, v240
    buffer_store_dwordx4 v[168:171], v2, s[28:31], s66 offen offset:1024 sc1
    v_rcp_f32 v241, v241
    v_rcp_f32 v242, v242
    s_barrier
    ds_read_b128 v[84:87], v122
    ds_read_b128 v[60:63], v4 offset:32768
    v_rcp_f32 v243, v243
    v_mul_f32 v240, v240, v200
    v_mul_f32 v241, v241, v201
    s_mov_b32 s54, 0x0000ffff
    s_mov_b32 s55, 0x0000ffff
    ds_read_b128 v[64:67], v4 offset:34816
    v_mul_f32 v242, v242, v202
    v_mul_f32 v243, v243, v203
    v_mul_f32 v240, v240, v216
    v_mul_f32 v241, v241, v217
    s_mov_b64 exec, s[54:55]
    ds_read_b128 v[68:71], v5 offset:32768
    ds_read_b128 v[72:75], v5 offset:33280
    s_mov_b64 exec, -1
    v_mul_f32 v242, v242, v218
    v_mul_f32 v243, v243, v219
    v_cvt_pk_bf16_f32 v200, v240, v241
    v_cvt_pk_bf16_f32 v201, v242, v243
    v_fma_f32 v244, v244, v102, v102
    v_fma_f32 v245, v245, v102, v102
    v_fma_f32 v246, v246, v102, v102
    v_fma_f32 v247, v247, v102, v102
    v_rcp_f32 v244, v244
    buffer_store_dwordx4 v[192:195], v2, s[28:31], s65 offen offset:2048 sc1
    v_rcp_f32 v245, v245
    s_waitcnt lgkmcnt(3)
    v_mfma_f32_32x32x16_bf16 v[12:27], v[60:63], v[84:87], 0
    v_rcp_f32 v246, v246
    v_rcp_f32 v247, v247
    v_mul_f32 v244, v244, v204
    v_mul_f32 v245, v245, v205
    v_mul_f32 v246, v246, v206
    v_mul_f32 v247, v247, v207
    v_mul_f32 v244, v244, v220
    v_mul_f32 v245, v245, v221
    v_mul_f32 v246, v246, v222
    v_mul_f32 v247, v247, v223
    v_cvt_pk_bf16_f32 v202, v244, v245
    v_cvt_pk_bf16_f32 v203, v246, v247
    s_nop 1
    v_permlane16_swap_b32 v200, v202
    v_permlane16_swap_b32 v201, v203
    buffer_store_dwordx4 v[200:203], v2, s[28:31], s66 offen offset:2048 sc1
LA_join:
    s_lshl_b32 s63, s3, 12
    s_add_u32 s63, s63, 0x20000
    s_lshl_b32 s67, s3, 14
    s_lshl_b32 s69, s6, 3
    s_add_u32 s69, s69, s7
    s_lshl_b32 s69, s69, 14
    s_mul_i32 s10, s56, 176128
    s_add_u32 s8, s58, 4194304
    s_add_u32 s64, s10, s8
    s_cmp_ge_u32 s3, 6
    s_cselect_b32 s71, 16777216, 0
    s_lshr_b32 s72, s56, 1
    s_lshl_b32 s72, s72, 7
    s_add_u32 s72, s72, 163840
    v_exp_f32 v12, v12
    v_exp_f32 v13, v13
    s_setprio 0
    s_waitcnt lgkmcnt(0)
    v_exp_f32 v14, v14
    v_exp_f32 v15, v15
    v_exp_f32 v16, v16
    ds_read_b128 v[60:63], v4 offset:36864
    v_mfma_f32_32x32x16_bf16 v[28:43], v[64:67], v[84:87], 0
    v_exp_f32 v17, v17
    v_exp_f32 v18, v18
    v_exp_f32 v19, v19
    v_exp_f32 v20, v20
    v_exp_f32 v21, v21
    v_exp_f32 v22, v22
    s_mov_b64 exec, s[54:55]
    ds_read_b128 v[76:79], v5 offset:34816
    ds_read_b128 v[80:83], v5 offset:35328
    s_mov_b64 exec, -1
    v_smfmac_f32_32x32x32_bf16 v[44:59], v[68:71], v[12:19], v8
    v_exp_f32 v23, v23
    v_exp_f32 v24, v24
    v_exp_f32 v25, v25
    v_exp_f32 v26, v26
    v_exp_f32 v27, v27
    v_exp_f32 v28, v28
    v_exp_f32 v29, v29
    s_setprio 3
    s_waitcnt lgkmcnt(0)
    v_smfmac_f32_32x32x32_bf16 v[44:59], v[72:75], v[20:27], v8
    v_exp_f32 v30, v30
    v_exp_f32 v31, v31
    v_exp_f32 v32, v32
    ds_read_b128 v[64:67], v4 offset:38912
    v_mfma_f32_32x32x16_bf16 v[12:27], v[60:63], v[84:87], 0
    v_exp_f32 v33, v33
    v_exp_f32 v34, v34
    v_exp_f32 v35, v35
    v_exp_f32 v36, v36
    v_exp_f32 v37, v37
    v_exp_f32 v38, v38
    s_mov_b64 exec, s[54:55]
    ds_read_b128 v[68:71], v5 offset:36864
    ds_read_b128 v[72:75], v5 offset:37376
    s_mov_b64 exec, -1
    v_smfmac_f32_32x32x32_bf16 v[44:59], v[76:79], v[28:35], v8
    v_exp_f32 v39, v39
    v_exp_f32 v40, v40
    v_exp_f32 v41, v41
    s_lshl_b32 s8, s2, 13
    s_add_u32 s8, s8, s58
    buffer_load_dwordx4 v[124:127], v2, s[32:35], s8 offen
    v_exp_f32 v42, v42
    v_exp_f32 v43, v43
    v_exp_f32 v12, v12
    v_exp_f32 v13, v13
    s_setprio 2
    s_waitcnt lgkmcnt(0)
    v_smfmac_f32_32x32x32_bf16 v[44:59], v[80:83], v[36:43], v8
    v_exp_f32 v14, v14
    v_exp_f32 v15, v15
    v_exp_f32 v16, v16
    ds_read_b128 v[60:63], v4 offset:40960
    v_mfma_f32_32x32x16_bf16 v[28:43], v[64:67], v[84:87], 0
    v_exp_f32 v17, v17
    v_exp_f32 v18, v18
    v_exp_f32 v19, v19
    v_exp_f32 v20, v20
    v_exp_f32 v21, v21
    v_exp_f32 v22, v22
    s_mov_b64 exec, s[54:55]
    ds_read_b128 v[76:79], v5 offset:38912
    ds_read_b128 v[80:83], v5 offset:39424
    s_mov_b64 exec, -1
    v_smfmac_f32_32x32x32_bf16 v[44:59], v[68:71], v[12:19], v8
    v_exp_f32 v23, v23
    v_exp_f32 v24, v24
    v_exp_f32 v25, v25
    s_lshl_b32 s8, s2, 13
    s_add_u32 s8, s8, s58
    s_sub_u32 s8, s8, 1572864
    s_cselect_b32 s8, 524288, s8
    buffer_load_dwordx4 v[124:127], v2, s[36:39], s8 offen
    v_exp_f32 v26, v26
    v_exp_f32 v27, v27
    v_exp_f32 v28, v28
    v_exp_f32 v29, v29
    s_setprio 1
    s_waitcnt lgkmcnt(0)
    v_smfmac_f32_32x32x32_bf16 v[44:59], v[72:75], v[20:27], v8
    v_exp_f32 v30, v30
    v_exp_f32 v31, v31
    v_exp_f32 v32, v32
    ds_read_b128 v[64:67], v4 offset:43008
    v_mfma_f32_32x32x16_bf16 v[12:27], v[60:63], v[84:87], 0
    v_exp_f32 v33, v33
    v_exp_f32 v34, v34
    v_exp_f32 v35, v35
    v_exp_f32 v36, v36
    v_exp_f32 v37, v37
    v_exp_f32 v38, v38
    s_mov_b64 exec, s[54:55]
    ds_read_b128 v[68:71], v5 offset:40960
    ds_read_b128 v[72:75], v5 offset:41472
    s_mov_b64 exec, -1
    v_smfmac_f32_32x32x32_bf16 v[44:59], v[76:79], v[28:35], v8
    v_exp_f32 v39, v39
    v_exp_f32 v40, v40
    v_exp_f32 v41, v41
    s_add_u32 s8, s73, 32768
    s_add_u32 m0, s58, 32768
    s_and_b32 s8, s8, 0x1ffff
    buffer_load_dwordx4 v2, s[28:31], s8 offen sc1 lds
    v_exp_f32 v42, v42
    v_exp_f32 v43, v43
    v_exp_f32 v12, v12
    v_exp_f32 v13, v13
    s_setprio 0
    s_waitcnt lgkmcnt(0)
    v_smfmac_f32_32x32x32_bf16 v[44:59], v[80:83], v[36:43], v8
    v_exp_f32 v14, v14
    v_exp_f32 v15, v15
    v_exp_f32 v16, v16
    ds_read_b128 v[60:63], v4 offset:45056
    v_mfma_f32_32x32x16_bf16 v[28:43], v[64:67], v[84:87], 0
    v_exp_f32 v17, v17
    v_exp_f32 v18, v18
    v_exp_f32 v19, v19
    v_exp_f32 v20, v20
    v_exp_f32 v21, v21
    v_exp_f32 v22, v22
    s_mov_b64 exec, s[54:55]
    ds_read_b128 v[76:79], v5 offset:43008
    ds_read_b128 v[80:83], v5 offset:43520
    s_mov_b64 exec, -1
    v_smfmac_f32_32x32x32_bf16 v[44:59], v[68:71], v[12:19], v8
    v_exp_f32 v23, v23
    v_exp_f32 v24, v24
    v_exp_f32 v25, v25
    s_add_u32 s8, s73, 40960
    s_add_u32 m0, s58, 40960
    s_and_b32 s8, s8, 0x1ffff
    buffer_load_dwordx4 v2, s[28:31], s8 offen sc1 lds
    v_exp_f32 v26, v26
    v_exp_f32 v27, v27
    v_exp_f32 v28, v28
    v_exp_f32 v29, v29
    s_setprio 3
    s_waitcnt lgkmcnt(0)
    v_smfmac_f32_32x32x32_bf16 v[44:59], v[72:75], v[20:27], v8
    v_exp_f32 v30, v30
    v_exp_f32 v31, v31
    v_exp_f32 v32, v32
    ds_read_b128 v[64:67], v4 offset:47104
    v_mfma_f32_32x32x16_bf16 v[12:27], v[60:63], v[84:87], 0
    v_exp_f32 v33, v33
    v_exp_f32 v34, v34
    v_exp_f32 v35, v35
    v_exp_f32 v36, v36
    v_exp_f32 v37, v37
    v_exp_f32 v38, v38
    s_mov_b64 exec, s[54:55]
    ds_read_b128 v[68:71], v5 offset:45056
    ds_read_b128 v[72:75], v5 offset:45568
    s_mov_b64 exec, -1
    v_smfmac_f32_32x32x32_bf16 v[44:59], v[76:79], v[28:35], v8
    v_exp_f32 v39, v39
    v_exp_f32 v40, v40
    v_exp_f32 v41, v41
    s_add_u32 s8, s73, 49152
    s_add_u32 m0, s58, 49152
    s_and_b32 s8, s8, 0x1ffff
    buffer_load_dwordx4 v2, s[28:31], s8 offen sc1 lds
    v_exp_f32 v42, v42
    v_exp_f32 v43, v43
    v_exp_f32 v12, v12
    v_exp_f32 v13, v13
    s_setprio 2
    s_waitcnt lgkmcnt(0)
    v_smfmac_f32_32x32x32_bf16 v[44:59], v[80:83], v[36:43], v8
    v_exp_f32 v14, v14
    v_exp_f32 v15, v15
    v_exp_f32 v16, v16
    ds_read_b128 v[60:63], v4 offset:49152
    v_mfma_f32_32x32x16_bf16 v[28:43], v[64:67], v[84:87], 0
    v_exp_f32 v17, v17
    v_exp_f32 v18, v18
    v_exp_f32 v19, v19
    v_exp_f32 v20, v20
    v_exp_f32 v21, v21
    v_exp_f32 v22, v22
    s_mov_b64 exec, s[54:55]
    ds_read_b128 v[76:79], v5 offset:47104
    ds_read_b128 v[80:83], v5 offset:47616
    s_mov_b64 exec, -1
    v_smfmac_f32_32x32x32_bf16 v[44:59], v[68:71], v[12:19], v8
    v_exp_f32 v23, v23
    v_exp_f32 v24, v24
    v_exp_f32 v25, v25
    s_add_u32 s8, s73, 57344
    s_add_u32 m0, s58, 57344
    s_and_b32 s8, s8, 0x1ffff
    buffer_load_dwordx4 v2, s[28:31], s8 offen sc1 lds
    v_exp_f32 v26, v26
    v_exp_f32 v27, v27
    v_exp_f32 v28, v28
    v_exp_f32 v29, v29
    s_setprio 1
    s_waitcnt lgkmcnt(0)
    v_smfmac_f32_32x32x32_bf16 v[44:59], v[72:75], v[20:27], v8
    v_exp_f32 v30, v30
    v_exp_f32 v31, v31
    v_exp_f32 v32, v32
    ds_read_b128 v[64:67], v4 offset:51200
    v_mfma_f32_32x32x16_bf16 v[12:27], v[60:63], v[84:87], 0
    v_exp_f32 v33, v33
    v_exp_f32 v34, v34
    v_exp_f32 v35, v35
    v_exp_f32 v36, v36
    v_exp_f32 v37, v37
    v_exp_f32 v38, v38
    s_mov_b64 exec, s[54:55]
    ds_read_b128 v[68:71], v5 offset:49152
    ds_read_b128 v[72:75], v5 offset:49664
    s_mov_b64 exec, -1
    v_smfmac_f32_32x32x32_bf16 v[44:59], v[76:79], v[28:35], v8
    v_exp_f32 v39, v39
    v_exp_f32 v40, v40
    v_exp_f32 v41, v41
    s_add_u32 s8, s73, 65536
    s_add_u32 m0, s58, 65536
    s_and_b32 s8, s8, 0x1ffff
    buffer_load_dwordx4 v2, s[28:31], s8 offen sc1 lds
    v_exp_f32 v42, v42
    v_exp_f32 v43, v43
    v_exp_f32 v12, v12
    v_exp_f32 v13, v13
    s_setprio 0
    s_waitcnt lgkmcnt(0)
    v_smfmac_f32_32x32x32_bf16 v[44:59], v[80:83], v[36:43], v8
    v_exp_f32 v14, v14
    v_exp_f32 v15, v15
    v_exp_f32 v16, v16
    ds_read_b128 v[60:63], v4 offset:53248
    v_mfma_f32_32x32x16_bf16 v[28:43], v[64:67], v[84:87], 0
    v_exp_f32 v17, v17
    v_exp_f32 v18, v18
    v_exp_f32 v19, v19
    v_exp_f32 v20, v20
    v_exp_f32 v21, v21
    v_exp_f32 v22, v22
    s_mov_b64 exec, s[54:55]
    ds_read_b128 v[76:79], v5 offset:51200
    ds_read_b128 v[80:83], v5 offset:51712
    s_mov_b64 exec, -1
    v_smfmac_f32_32x32x32_bf16 v[44:59], v[68:71], v[12:19], v8
    v_exp_f32 v23, v23
    v_exp_f32 v24, v24
    v_exp_f32 v25, v25
    s_add_u32 s8, s73, 73728
    s_add_u32 m0, s58, 73728
    s_and_b32 s8, s8, 0x1ffff
    buffer_load_dwordx4 v2, s[28:31], s8 offen sc1 lds
    v_exp_f32 v26, v26
    v_exp_f32 v27, v27
    v_exp_f32 v28, v28
    v_exp_f32 v29, v29
    s_setprio 3
    s_waitcnt lgkmcnt(0)
    v_smfmac_f32_32x32x32_bf16 v[44:59], v[72:75], v[20:27], v8
    v_exp_f32 v30, v30
    v_exp_f32 v31, v31
    v_exp_f32 v32, v32
    ds_read_b128 v[64:67], v4 offset:55296
    v_mfma_f32_32x32x16_bf16 v[12:27], v[60:63], v[84:87], 0
    v_exp_f32 v33, v33
    v_exp_f32 v34, v34
    v_exp_f32 v35, v35
    v_exp_f32 v36, v36
    v_exp_f32 v37, v37
    v_exp_f32 v38, v38
    s_mov_b64 exec, s[54:55]
    ds_read_b128 v[68:71], v5 offset:53248
    ds_read_b128 v[72:75], v5 offset:53760
    s_mov_b64 exec, -1
    v_smfmac_f32_32x32x32_bf16 v[44:59], v[76:79], v[28:35], v8
    v_exp_f32 v39, v39
    v_exp_f32 v40, v40
    v_exp_f32 v41, v41
    s_add_u32 s8, s73, 81920
    s_add_u32 m0, s58, 81920
    s_and_b32 s8, s8, 0x1ffff
    buffer_load_dwordx4 v2, s[28:31], s8 offen sc1 lds
    v_exp_f32 v42, v42
    v_exp_f32 v43, v43
    v_exp_f32 v12, v12
    v_exp_f32 v13, v13
    s_setprio 2
    s_waitcnt lgkmcnt(0)
    v_smfmac_f32_32x32x32_bf16 v[44:59], v[80:83], v[36:43], v8
    v_exp_f32 v14, v14
    v_exp_f32 v15, v15
    v_exp_f32 v16, v16
    ds_read_b128 v[60:63], v4 offset:57344
    v_mfma_f32_32x32x16_bf16 v[28:43], v[64:67], v[84:87], 0
    v_exp_f32 v17, v17
    v_exp_f32 v18, v18
    v_exp_f32 v19, v19
    v_exp_f32 v20, v20
    v_exp_f32 v21, v21
    v_exp_f32 v22, v22
    s_mov_b64 exec, s[54:55]
    ds_read_b128 v[76:79], v5 offset:55296
    ds_read_b128 v[80:83], v5 offset:55808
    s_mov_b64 exec, -1
    v_smfmac_f32_32x32x32_bf16 v[44:59], v[68:71], v[12:19], v8
    v_exp_f32 v23, v23
    v_exp_f32 v24, v24
    v_exp_f32 v25, v25
    s_add_u32 s8, s73, 90112
    s_add_u32 m0, s58, 90112
    s_and_b32 s8, s8, 0x1ffff
    buffer_load_dwordx4 v2, s[28:31], s8 offen sc1 lds
    v_exp_f32 v26, v26
    v_exp_f32 v27, v27
    v_exp_f32 v28, v28
    v_exp_f32 v29, v29
    s_setprio 1
    s_waitcnt lgkmcnt(0)
    v_smfmac_f32_32x32x32_bf16 v[44:59], v[72:75], v[20:27], v8
    v_exp_f32 v30, v30
    v_exp_f32 v31, v31
    v_exp_f32 v32, v32
    ds_read_b128 v[64:67], v4 offset:59392
    v_mfma_f32_32x32x16_bf16 v[12:27], v[60:63], v[84:87], 0
    v_exp_f32 v33, v33
    v_exp_f32 v34, v34
    v_exp_f32 v35, v35
    v_exp_f32 v36, v36
    v_exp_f32 v37, v37
    v_exp_f32 v38, v38
    s_mov_b64 exec, s[54:55]
    ds_read_b128 v[68:71], v5 offset:57344
    ds_read_b128 v[72:75], v5 offset:57856
    s_mov_b64 exec, -1
    v_smfmac_f32_32x32x32_bf16 v[44:59], v[76:79], v[28:35], v8
    v_exp_f32 v39, v39
    v_exp_f32 v40, v40
    v_exp_f32 v41, v41
    s_add_u32 m0, s63, 0
    s_add_u32 s8, s69, 0
    buffer_load_dwordx4 v7, s[36:39], s8 offen lds
    v_exp_f32 v42, v42
    v_exp_f32 v43, v43
    v_exp_f32 v12, v12
    v_exp_f32 v13, v13
    s_setprio 0
    s_waitcnt lgkmcnt(0)
    v_smfmac_f32_32x32x32_bf16 v[44:59], v[80:83], v[36:43], v8
    v_exp_f32 v14, v14
    v_exp_f32 v15, v15
    v_exp_f32 v16, v16
    ds_read_b128 v[60:63], v4 offset:61440
    v_mfma_f32_32x32x16_bf16 v[28:43], v[64:67], v[84:87], 0
    v_exp_f32 v17, v17
    v_exp_f32 v18, v18
    v_exp_f32 v19, v19
    v_exp_f32 v20, v20
    v_exp_f32 v21, v21
    v_exp_f32 v22, v22
    s_mov_b64 exec, s[54:55]
    ds_read_b128 v[76:79], v5 offset:59392
    ds_read_b128 v[80:83], v5 offset:59904
    s_mov_b64 exec, -1
    v_smfmac_f32_32x32x32_bf16 v[44:59], v[68:71], v[12:19], v8
    v_exp_f32 v23, v23
    v_exp_f32 v24, v24
    v_exp_f32 v25, v25
    s_add_u32 m0, s63, 1024
    s_add_u32 s8, s69, 64
    buffer_load_dwordx4 v7, s[36:39], s8 offen lds
    v_exp_f32 v26, v26
    v_exp_f32 v27, v27
    s_waitcnt vmcnt(2)
    s_barrier
    s_mov_b64 exec, 1
    buffer_store_dword v8, v2, s[28:31], s77 offen sc1
    s_mov_b64 exec, -1
    v_exp_f32 v28, v28
    v_exp_f32 v29, v29
    s_setprio 2
    s_waitcnt lgkmcnt(0)
    v_smfmac_f32_32x32x32_bf16 v[44:59], v[72:75], v[20:27], v8
    v_exp_f32 v30, v30
    v_exp_f32 v31, v31
    v_exp_f32 v32, v32
    ds_read_b128 v[64:67], v4 offset:63488
    v_mfma_f32_32x32x16_bf16 v[12:27], v[60:63], v[84:87], 0
    v_exp_f32 v33, v33
    v_exp_f32 v34, v34
    v_exp_f32 v35, v35
    v_exp_f32 v36, v36
    v_exp_f32 v37, v37
    v_exp_f32 v38, v38
    s_mov_b64 exec, s[54:55]
    ds_read_b128 v[68:71], v5 offset:61440
    ds_read_b128 v[72:75], v5 offset:61952
    s_mov_b64 exec, -1
    v_smfmac_f32_32x32x32_bf16 v[44:59], v[76:79], v[28:35], v8
    v_exp_f32 v39, v39
    v_exp_f32 v40, v40
    v_exp_f32 v41, v41
    s_add_u32 m0, s63, 2048
    s_add_u32 s8, s69, 32768
    buffer_load_dwordx4 v7, s[36:39], s8 offen lds
    v_exp_f32 v42, v42
    v_exp_f32 v43, v43
    v_exp_f32 v12, v12
    v_exp_f32 v13, v13
    s_setprio 1
    s_waitcnt lgkmcnt(0)
    v_smfmac_f32_32x32x32_bf16 v[44:59], v[80:83], v[36:43], v8
    v_exp_f32 v14, v14
    v_exp_f32 v15, v15
    v_exp_f32 v16, v16
    ds_read_b128 v[60:63], v2 offset:0
    s_waitcnt vmcnt(3)
    ds_read_b64_tr_b16 v[192:193], v6 offset:0
    ds_read_b64_tr_b16 v[194:195], v6 offset:512
    v_mfma_f32_32x32x16_bf16 v[28:43], v[64:67], v[84:87], 0
    v_exp_f32 v17, v17
    v_exp_f32 v18, v18
    v_exp_f32 v19, v19
    v_exp_f32 v20, v20
    v_exp_f32 v21, v21
    v_exp_f32 v22, v22
    s_mov_b64 exec, s[54:55]
    ds_read_b128 v[76:79], v5 offset:63488
    ds_read_b128 v[80:83], v5 offset:64000
    s_mov_b64 exec, -1
    v_smfmac_f32_32x32x32_bf16 v[44:59], v[68:71], v[12:19], v8
    v_exp_f32 v23, v23
    v_exp_f32 v24, v24
    v_exp_f32 v25, v25
    s_add_u32 m0, s63, 3072
    s_add_u32 s8, s69, 32832
    buffer_load_dwordx4 v7, s[36:39], s8 offen lds
    v_exp_f32 v26, v26
    v_exp_f32 v27, v27
    v_exp_f32 v28, v28
    v_exp_f32 v29, v29
    s_setprio 0
    s_waitcnt lgkmcnt(0)
    v_smfmac_f32_32x32x32_bf16 v[44:59], v[72:75], v[20:27], v8
    v_exp_f32 v30, v30
    v_exp_f32 v31, v31
    v_exp_f32 v32, v32
    ds_read_b128 v[64:67], v2 offset:2048
    s_waitcnt vmcnt(3)
    ds_read_b64_tr_b16 v[196:197], v6 offset:1024
    ds_read_b64_tr_b16 v[198:199], v6 offset:1536
    v_mfma_f32_32x32x16_bf16 v[12:27], v[60:63], v[84:87], 0
    v_exp_f32 v33, v33
    v_exp_f32 v34, v34
    v_exp_f32 v35, v35
    v_exp_f32 v36, v36
    v_exp_f32 v37, v37
    v_exp_f32 v38, v38
    s_mov_b64 exec, s[54:55]
    ds_read_b128 v[68:71], v3 offset:0
    ds_read_b128 v[72:75], v3 offset:512
    s_mov_b64 exec, -1
    v_smfmac_f32_32x32x32_bf16 v[44:59], v[76:79], v[28:35], v8
    v_exp_f32 v39, v39
    v_exp_f32 v40, v40
    v_exp_f32 v41, v41
    s_add_u32 m0, s63, 0
    s_add_u32 s8, s69, 65536
    buffer_load_dwordx4 v7, s[36:39], s8 offen lds
    v_exp_f32 v42, v42
    v_exp_f32 v43, v43
    v_exp_f32 v12, v12
    v_exp_f32 v13, v13
    s_setprio 3
    s_waitcnt lgkmcnt(0)
    v_smfmac_f32_32x32x32_bf16 v[44:59], v[80:83], v[36:43], v8
    v_exp_f32 v14, v14
    v_exp_f32 v15, v15
    v_exp_f32 v16, v16
    ds_read_b128 v[60:63], v2 offset:4096
    s_waitcnt vmcnt(2)
    ds_read_b64_tr_b16 v[200:201], v6 offset:2048
    ds_read_b64_tr_b16 v[202:203], v6 offset:2560
    v_mfma_f32_32x32x16_bf16 v[28:43], v[64:67], v[84:87], 0
    v_exp_f32 v17, v17
    v_exp_f32 v18, v18
    v_exp_f32 v19, v19
    v_exp_f32 v20, v20
    v_exp_f32 v21, v21
    v_exp_f32 v22, v22
    s_mov_b64 exec, s[54:55]
    ds_read_b128 v[76:79], v3 offset:2048
    ds_read_b128 v[80:83], v3 offset:2560
    s_mov_b64 exec, -1
    v_smfmac_f32_32x32x32_bf16 v[44:59], v[68:71], v[12:19], v8
    v_exp_f32 v23, v23
    v_exp_f32 v24, v24
    v_exp_f32 v25, v25
    s_add_u32 m0, s63, 1024
    s_add_u32 s8, s69, 65600
    buffer_load_dwordx4 v7, s[36:39], s8 offen lds
    v_exp_f32 v26, v26
    v_exp_f32 v27, v27
    v_exp_f32 v28, v28
    v_exp_f32 v29, v29
    s_setprio 2
    s_waitcnt lgkmcnt(0)
    v_smfmac_f32_32x32x32_bf16 v[44:59], v[72:75], v[20:27], v8
    v_exp_f32 v30, v30
    v_exp_f32 v31, v31
    v_exp_f32 v32, v32
    ds_read_b128 v[64:67], v2 offset:6144
    s_waitcnt vmcnt(2)
    ds_read_b64_tr_b16 v[204:205], v6 offset:3072
    ds_read_b64_tr_b16 v[206:207], v6 offset:3584
    v_mfma_f32_32x32x16_bf16 v[12:27], v[60:63], v[84:87], 0
    v_exp_f32 v33, v33
    v_exp_f32 v34, v34
    v_exp_f32 v35, v35
    v_exp_f32 v36, v36
    v_exp_f32 v37, v37
    v_exp_f32 v38, v38
    s_mov_b64 exec, s[54:55]
    ds_read_b128 v[68:71], v3 offset:4096
    ds_read_b128 v[72:75], v3 offset:4608
    s_mov_b64 exec, -1
    v_smfmac_f32_32x32x32_bf16 v[44:59], v[76:79], v[28:35], v8
    v_exp_f32 v39, v39
    v_exp_f32 v40, v40
    v_exp_f32 v41, v41
    s_add_u32 m0, s63, 2048
    s_add_u32 s8, s69, 98304
    buffer_load_dwordx4 v7, s[36:39], s8 offen lds
    v_exp_f32 v42, v42
    v_exp_f32 v43, v43
    v_exp_f32 v12, v12
    v_exp_f32 v13, v13
    s_setprio 1
    s_waitcnt lgkmcnt(0)
    v_smfmac_f32_32x32x32_bf16 v[44:59], v[80:83], v[36:43], v8
    v_exp_f32 v14, v14
    v_exp_f32 v15, v15
    v_exp_f32 v16, v16
    ds_read_b128 v[60:63], v2 offset:8192
    s_waitcnt vmcnt(2)
    ds_read_b64_tr_b16 v[208:209], v6 offset:0
    ds_read_b64_tr_b16 v[210:211], v6 offset:512
    v_mfma_f32_32x32x16_bf16 v[28:43], v[64:67], v[84:87], 0
    v_exp_f32 v17, v17
    v_exp_f32 v18, v18
    v_exp_f32 v19, v19
    v_exp_f32 v20, v20
    v_exp_f32 v21, v21
    v_exp_f32 v22, v22
    s_mov_b64 exec, s[54:55]
    ds_read_b128 v[76:79], v3 offset:6144
    ds_read_b128 v[80:83], v3 offset:6656
    s_mov_b64 exec, -1
    v_smfmac_f32_32x32x32_bf16 v[44:59], v[68:71], v[12:19], v8
    v_exp_f32 v23, v23
    v_exp_f32 v24, v24
    v_exp_f32 v25, v25
    s_add_u32 m0, s63, 3072
    s_add_u32 s8, s69, 98368
    buffer_load_dwordx4 v7, s[36:39], s8 offen lds
    v_exp_f32 v26, v26
    v_exp_f32 v27, v27
    v_exp_f32 v28, v28
    v_exp_f32 v29, v29
    s_setprio 0
    s_waitcnt lgkmcnt(0)
    v_smfmac_f32_32x32x32_bf16 v[44:59], v[72:75], v[20:27], v8
    v_exp_f32 v30, v30
    v_exp_f32 v31, v31
    v_exp_f32 v32, v32
    ds_read_b128 v[64:67], v2 offset:10240
    s_waitcnt vmcnt(2)
    ds_read_b64_tr_b16 v[212:213], v6 offset:1024
    ds_read_b64_tr_b16 v[214:215], v6 offset:1536
    v_mfma_f32_32x32x16_bf16 v[12:27], v[60:63], v[84:87], 0
    v_exp_f32 v33, v33
    v_exp_f32 v34, v34
    v_exp_f32 v35, v35
    v_exp_f32 v36, v36
    v_exp_f32 v37, v37
    v_exp_f32 v38, v38
    s_mov_b64 exec, s[54:55]
    ds_read_b128 v[68:71], v3 offset:8192
    ds_read_b128 v[72:75], v3 offset:8704
    s_mov_b64 exec, -1
    v_smfmac_f32_32x32x32_bf16 v[44:59], v[76:79], v[28:35], v8
    v_exp_f32 v39, v39
    v_exp_f32 v40, v40
    v_exp_f32 v41, v41
    s_add_u32 m0, s63, 0
    s_add_u32 s8, s67, 1048576
    buffer_load_dwordx4 v7, s[32:35], s8 offen lds
    v_exp_f32 v42, v42
    v_exp_f32 v43, v43
    v_exp_f32 v12, v12
    v_exp_f32 v13, v13
    s_setprio 3
    s_waitcnt lgkmcnt(0)
    v_smfmac_f32_32x32x32_bf16 v[44:59], v[80:83], v[36:43], v8
    v_exp_f32 v14, v14
    v_exp_f32 v15, v15
    v_exp_f32 v16, v16
    ds_read_b128 v[60:63], v2 offset:12288
    s_waitcnt vmcnt(2)
    ds_read_b64_tr_b16 v[216:217], v6 offset:2048
    ds_read_b64_tr_b16 v[218:219], v6 offset:2560
    v_mfma_f32_32x32x16_bf16 v[28:43], v[64:67], v[84:87], 0
    v_exp_f32 v17, v17
    v_exp_f32 v18, v18
    v_exp_f32 v19, v19
    v_exp_f32 v20, v20
    v_exp_f32 v21, v21
    v_exp_f32 v22, v22
    s_mov_b64 exec, s[54:55]
    ds_read_b128 v[76:79], v3 offset:10240
    ds_read_b128 v[80:83], v3 offset:10752
    s_mov_b64 exec, -1
    v_smfmac_f32_32x32x32_bf16 v[44:59], v[68:71], v[12:19], v8
    v_exp_f32 v23, v23
    v_exp_f32 v24, v24
    v_exp_f32 v25, v25
    s_add_u32 m0, s63, 1024
    s_add_u32 s8, s67, 1048640
    buffer_load_dwordx4 v7, s[32:35], s8 offen lds
    v_exp_f32 v26, v26
    v_exp_f32 v27, v27
    v_exp_f32 v28, v28
    v_exp_f32 v29, v29
    s_setprio 2
    s_waitcnt lgkmcnt(0)
    v_smfmac_f32_32x32x32_bf16 v[44:59], v[72:75], v[20:27], v8
    v_exp_f32 v30, v30
    v_exp_f32 v31, v31
    v_exp_f32 v32, v32
    ds_read_b128 v[64:67], v2 offset:14336
    s_waitcnt vmcnt(2)
    ds_read_b64_tr_b16 v[220:221], v6 offset:3072
    ds_read_b64_tr_b16 v[222:223], v6 offset:3584
    v_mfma_f32_32x32x16_bf16 v[12:27], v[60:63], v[84:87], 0
    v_exp_f32 v33, v33
    v_exp_f32 v34, v34
    v_exp_f32 v35, v35
    v_exp_f32 v36, v36
    v_exp_f32 v37, v37
    v_exp_f32 v38, v38
    s_mov_b64 exec, s[54:55]
    ds_read_b128 v[68:71], v3 offset:12288
    ds_read_b128 v[72:75], v3 offset:12800
    s_mov_b64 exec, -1
    v_smfmac_f32_32x32x32_bf16 v[44:59], v[76:79], v[28:35], v8
    v_exp_f32 v39, v39
    v_exp_f32 v40, v40
    v_exp_f32 v41, v41
    s_add_u32 m0, s63, 2048
    s_add_u32 s8, s67, 1179648
    buffer_load_dwordx4 v7, s[32:35], s8 offen lds
    v_exp_f32 v42, v42
    v_exp_f32 v43, v43
    v_exp_f32 v12, v12
    v_exp_f32 v13, v13
    s_setprio 1
    s_waitcnt lgkmcnt(0)
    v_smfmac_f32_32x32x32_bf16 v[44:59], v[80:83], v[36:43], v8
    v_exp_f32 v14, v14
    v_exp_f32 v15, v15
    v_exp_f32 v16, v16
    ds_read_b128 v[60:63], v2 offset:16384
    s_waitcnt vmcnt(2)
    ds_read_b64_tr_b16 v[224:225], v9 offset:0
    ds_read_b64_tr_b16 v[226:227], v9 offset:256
    v_mfma_f32_32x32x16_bf16 v[28:43], v[64:67], v[84:87], 0
    v_exp_f32 v17, v17
    v_exp_f32 v18, v18
    v_exp_f32 v19, v19
    s_add_u32 m0, s63, 3072
    s_add_u32 s8, s67, 1179712
    buffer_load_dwordx4 v7, s[32:35], s8 offen lds
    v_exp_f32 v20, v20
    v_exp_f32 v21, v21
    v_exp_f32 v22, v22
    s_mov_b64 exec, s[54:55]
    ds_read_b128 v[76:79], v3 offset:14336
    ds_read_b128 v[80:83], v3 offset:14848
    s_mov_b64 exec, -1
    v_smfmac_f32_32x32x32_bf16 v[44:59], v[68:71], v[12:19], v8
    v_exp_f32 v23, v23
    v_exp_f32 v24, v24
    v_exp_f32 v25, v25
    buffer_load_dword v121, v120, s[28:31], s72 offen sc1
    v_exp_f32 v26, v26
    v_exp_f32 v27, v27
    v_exp_f32 v28, v28
    v_exp_f32 v29, v29
    s_setprio 0
    s_waitcnt lgkmcnt(0)
    v_smfmac_f32_32x32x32_bf16 v[44:59], v[72:75], v[20:27], v8
    v_exp_f32 v30, v30
    v_exp_f32 v31, v31
    v_exp_f32 v32, v32
    ds_read_b128 v[64:67], v2 offset:18432
    s_waitcnt vmcnt(3)
    ds_read_b64_tr_b16 v[228:229], v9 offset:1024
    ds_read_b64_tr_b16 v[230:231], v9 offset:1280
    v_mfma_f32_32x32x16_bf16 v[12:27], v[60:63], v[84:87], 0
    v_exp_f32 v33, v33
    v_exp_f32 v34, v34
    v_exp_f32 v35, v35
    v_exp_f32 v36, v36
    v_exp_f32 v37, v37
    v_exp_f32 v38, v38
    s_mov_b64 exec, s[54:55]
    ds_read_b128 v[68:71], v3 offset:16384
    ds_read_b128 v[72:75], v3 offset:16896
    s_mov_b64 exec, -1
    v_smfmac_f32_32x32x32_bf16 v[44:59], v[76:79], v[28:35], v8
    v_exp_f32 v39, v39
    v_exp_f32 v40, v40
    v_exp_f32 v41, v41
    s_add_u32 m0, s63, 0
    s_add_u32 s8, s67, 1310720
    buffer_load_dwordx4 v7, s[32:35], s8 offen lds
    v_exp_f32 v42, v42
    v_exp_f32 v43, v43
    v_exp_f32 v12, v12
    v_exp_f32 v13, v13
    s_setprio 3
    s_waitcnt lgkmcnt(0)
    v_smfmac_f32_32x32x32_bf16 v[44:59], v[80:83], v[36:43], v8
    v_exp_f32 v14, v14
    v_exp_f32 v15, v15
    v_exp_f32 v16, v16
    ds_read_b128 v[60:63], v2 offset:20480
    s_waitcnt vmcnt(3)
    ds_read_b64_tr_b16 v[232:233], v9 offset:2048
    ds_read_b64_tr_b16 v[234:235], v9 offset:2304
    v_mfma_f32_32x32x16_bf16 v[28:43], v[64:67], v[84:87], 0
    v_exp_f32 v17, v17
    v_exp_f32 v18, v18
    v_exp_f32 v19, v19
    v_exp_f32 v20, v20
    v_exp_f32 v21, v21
    v_exp_f32 v22, v22
    s_mov_b64 exec, s[54:55]
    ds_read_b128 v[76:79], v3 offset:18432
    ds_read_b128 v[80:83], v3 offset:18944
    s_mov_b64 exec, -1
    v_smfmac_f32_32x32x32_bf16 v[44:59], v[68:71], v[12:19], v8
    v_exp_f32 v23, v23
    v_exp_f32 v24, v24
    v_exp_f32 v25, v25
    s_add_u32 m0, s63, 1024
    s_add_u32 s8, s67, 1310784
    buffer_load_dwordx4 v7, s[32:35], s8 offen lds
    v_exp_f32 v26, v26
    v_exp_f32 v27, v27
    v_exp_f32 v28, v28
    v_exp_f32 v29, v29
    s_setprio 2
    s_waitcnt lgkmcnt(0)
    v_smfmac_f32_32x32x32_bf16 v[44:59], v[72:75], v[20:27], v8
    v_exp_f32 v30, v30
    v_exp_f32 v31, v31
    v_exp_f32 v32, v32
    ds_read_b128 v[64:67], v2 offset:22528
    s_waitcnt vmcnt(3)
    ds_read_b64_tr_b16 v[236:237], v9 offset:3072
    ds_read_b64_tr_b16 v[238:239], v9 offset:3328
    s_waitcnt vmcnt(2)
    v_cmp_ne_u32 vcc, v8, v121
    s_cbranch_vccnz Lpoll_4
Lpok_5:
    v_mfma_f32_32x32x16_bf16 v[12:27], v[60:63], v[84:87], 0
    v_exp_f32 v33, v33
    v_exp_f32 v34, v34
    v_exp_f32 v35, v35
    v_exp_f32 v36, v36
    v_exp_f32 v37, v37
    v_exp_f32 v38, v38
    s_mov_b64 exec, s[54:55]
    ds_read_b128 v[68:71], v3 offset:20480
    ds_read_b128 v[72:75], v3 offset:20992
    s_mov_b64 exec, -1
    v_smfmac_f32_32x32x32_bf16 v[44:59], v[76:79], v[28:35], v8
    v_exp_f32 v39, v39
    v_exp_f32 v40, v40
    v_exp_f32 v41, v41
    s_add_u32 s8, s64, 0
    buffer_load_dwordx4 v[96:99], v2, s[28:31], s8 offen sc1 nt
    v_exp_f32 v42, v42
    v_exp_f32 v43, v43
    v_exp_f32 v12, v12
    v_exp_f32 v13, v13
    s_setprio 1
    s_waitcnt lgkmcnt(0)
    v_smfmac_f32_32x32x32_bf16 v[44:59], v[80:83], v[36:43], v8
    v_exp_f32 v14, v14
    v_exp_f32 v15, v15
    v_exp_f32 v16, v16
    ds_read_b128 v[60:63], v2 offset:24576
    s_waitcnt vmcnt(2)
    ds_read_b64_tr_b16 v[240:241], v9 offset:0
    ds_read_b64_tr_b16 v[242:243], v9 offset:256
    v_mfma_f32_32x32x16_bf16 v[28:43], v[64:67], v[84:87], 0
    v_exp_f32 v17, v17
    v_exp_f32 v18, v18
    v_exp_f32 v19, v19
    v_exp_f32 v20, v20
    v_exp_f32 v21, v21
    v_exp_f32 v22, v22
    s_mov_b64 exec, s[54:55]
    ds_read_b128 v[76:79], v3 offset:22528
    ds_read_b128 v[80:83], v3 offset:23040
    s_mov_b64 exec, -1
    v_smfmac_f32_32x32x32_bf16 v[44:59], v[68:71], v[12:19], v8
    v_exp_f32 v23, v23
    v_exp_f32 v24, v24
    v_exp_f32 v25, v25
    s_add_u32 s8, s64, 88064
    buffer_load_dwordx4 v[100:103], v2, s[28:31], s8 offen sc1 nt
    v_exp_f32 v26, v26
    v_exp_f32 v27, v27
    v_exp_f32 v28, v28
    v_exp_f32 v29, v29
    s_setprio 0
    s_waitcnt lgkmcnt(0)
    v_smfmac_f32_32x32x32_bf16 v[44:59], v[72:75], v[20:27], v8
    v_exp_f32 v30, v30
    v_exp_f32 v31, v31
    v_exp_f32 v32, v32
    ds_read_b128 v[64:67], v2 offset:26624
    s_waitcnt vmcnt(2)
    ds_read_b64_tr_b16 v[244:245], v9 offset:1024
    ds_read_b64_tr_b16 v[246:247], v9 offset:1280
    v_mfma_f32_32x32x16_bf16 v[12:27], v[60:63], v[84:87], 0
    v_exp_f32 v33, v33
    v_exp_f32 v34, v34
    v_exp_f32 v35, v35
    v_exp_f32 v36, v36
    v_exp_f32 v37, v37
    v_exp_f32 v38, v38
    s_mov_b64 exec, s[54:55]
    ds_read_b128 v[68:71], v3 offset:24576
    ds_read_b128 v[72:75], v3 offset:25088
    s_mov_b64 exec, -1
    v_smfmac_f32_32x32x32_bf16 v[44:59], v[76:79], v[28:35], v8
    v_exp_f32 v39, v39
    v_exp_f32 v40, v40
    v_exp_f32 v41, v41
    s_add_u32 m0, s63, 0
    s_add_u32 s8, s67, 0
    buffer_load_dwordx4 v7, s[32:35], s8 offen lds
    v_exp_f32 v42, v42
    v_exp_f32 v43, v43
    v_exp_f32 v12, v12
    v_exp_f32 v13, v13
    s_setprio 3
    s_waitcnt lgkmcnt(0)
    v_smfmac_f32_32x32x32_bf16 v[44:59], v[80:83], v[36:43], v8
    v_exp_f32 v14, v14
    v_exp_f32 v15, v15
    v_exp_f32 v16, v16
    ds_read_b128 v[60:63], v2 offset:28672
    v_mfma_f32_32x32x16_bf16 v[28:43], v[64:67], v[84:87], 0
    v_exp_f32 v17, v17
    v_exp_f32 v18, v18
    v_exp_f32 v19, v19
    v_exp_f32 v20, v20
    v_exp_f32 v21, v21
    v_exp_f32 v22, v22
    s_mov_b64 exec, s[54:55]
    ds_read_b128 v[76:79], v3 offset:26624
    ds_read_b128 v[80:83], v3 offset:27136
    s_mov_b64 exec, -1
    v_smfmac_f32_32x32x32_bf16 v[44:59], v[68:71], v[12:19], v8
    v_exp_f32 v23, v23
    v_exp_f32 v24, v24
    v_exp_f32 v25, v25
    s_add_u32 m0, s63, 1024
    s_add_u32 s8, s67, 64
    buffer_load_dwordx4 v7, s[32:35], s8 offen lds
    v_exp_f32 v26, v26
    v_exp_f32 v27, v27
    v_exp_f32 v28, v28
    v_exp_f32 v29, v29
    s_setprio 2
    s_waitcnt lgkmcnt(0)
    v_smfmac_f32_32x32x32_bf16 v[44:59], v[72:75], v[20:27], v8
    v_exp_f32 v30, v30
    v_exp_f32 v31, v31
    v_exp_f32 v32, v32
    ds_read_b128 v[64:67], v2 offset:30720
    v_mfma_f32_32x32x16_bf16 v[12:27], v[60:63], v[84:87], 0
    v_exp_f32 v33, v33
    v_exp_f32 v34, v34
    v_exp_f32 v35, v35
    s_add_u32 s8, s64, 8192
    buffer_load_dwordx4 v[104:107], v2, s[28:31], s8 offen sc1 nt
    v_exp_f32 v36, v36
    v_exp_f32 v37, v37
    v_exp_f32 v38, v38
    s_mov_b64 exec, s[54:55]
    ds_read_b128 v[68:71], v3 offset:28672
    ds_read_b128 v[72:75], v3 offset:29184
    s_mov_b64 exec, -1
    v_smfmac_f32_32x32x32_bf16 v[44:59], v[76:79], v[28:35], v8
    v_exp_f32 v39, v39
    v_exp_f32 v40, v40
    v_exp_f32 v41, v41
    s_lshr_b32 s8, s59, 2
    s_add_u32 s8, s8, 131072
    buffer_load_dword v10, v10, s[28:31], s8 offen offset:256 sc1
    v_exp_f32 v42, v42
    v_exp_f32 v43, v43
    v_exp_f32 v12, v12
    v_exp_f32 v13, v13
    s_setprio 1
    s_waitcnt lgkmcnt(0)
    v_smfmac_f32_32x32x32_bf16 v[44:59], v[80:83], v[36:43], v8
    v_exp_f32 v14, v14
    v_exp_f32 v15, v15
    v_exp_f32 v16, v16
    ds_read_b128 v[60:63], v2 offset:32768
    v_mfma_f32_32x32x16_bf16 v[28:43], v[64:67], v[84:87], 0
    v_exp_f32 v17, v17
    v_exp_f32 v18, v18
    v_exp_f32 v19, v19
    v_exp_f32 v20, v20
    v_exp_f32 v21, v21
    v_exp_f32 v22, v22
    s_mov_b64 exec, s[54:55]
    ds_read_b128 v[76:79], v3 offset:30720
    ds_read_b128 v[80:83], v3 offset:31232
    s_mov_b64 exec, -1
    v_smfmac_f32_32x32x32_bf16 v[44:59], v[68:71], v[12:19], v8
    v_exp_f32 v23, v23
    v_exp_f32 v24, v24
    v_exp_f32 v25, v25
    s_add_u32 s8, s64, 96256
    buffer_load_dwordx4 v[108:111], v2, s[28:31], s8 offen sc1 nt
    v_exp_f32 v26, v26
    v_exp_f32 v27, v27
    v_exp_f32 v28, v28
    v_exp_f32 v29, v29
    s_setprio 0
    s_waitcnt lgkmcnt(0)
    v_smfmac_f32_32x32x32_bf16 v[44:59], v[72:75], v[20:27], v8
    v_exp_f32 v30, v30
    v_exp_f32 v31, v31
    v_exp_f32 v32, v32
    ds_read_b128 v[64:67], v2 offset:34816
    s_waitcnt vmcnt(4)
    ds_read_b64_tr_b16 v[88:89], v9 offset:0
    ds_read_b64_tr_b16 v[90:91], v9 offset:256
    v_mfma_f32_32x32x16_bf16 v[12:27], v[60:63], v[84:87], 0
    v_exp_f32 v33, v33
    v_exp_f32 v34, v34
    v_exp_f32 v35, v35
    v_exp_f32 v36, v36
    v_exp_f32 v37, v37
    v_exp_f32 v38, v38
    s_mov_b64 exec, s[54:55]
    ds_read_b128 v[68:71], v3 offset:32768
    ds_read_b128 v[72:75], v3 offset:33280
    s_mov_b64 exec, -1
    v_smfmac_f32_32x32x32_bf16 v[44:59], v[76:79], v[28:35], v8
    v_exp_f32 v39, v39
    v_exp_f32 v40, v40
    v_exp_f32 v41, v41
    s_add_u32 m0, s63, 2048
    s_add_u32 s8, s67, 131072
    buffer_load_dwordx4 v7, s[32:35], s8 offen lds
    v_exp_f32 v42, v42
    v_exp_f32 v43, v43
    v_exp_f32 v12, v12
    v_exp_f32 v13, v13
    s_setprio 3
    s_waitcnt lgkmcnt(0)
    v_smfmac_f32_32x32x32_bf16 v[44:59], v[80:83], v[36:43], v8
    v_exp_f32 v14, v14
    v_exp_f32 v15, v15
    v_exp_f32 v16, v16
    ds_read_b128 v[60:63], v2 offset:36864
    v_mfma_f32_32x32x16_bf16 v[28:43], v[64:67], v[84:87], 0
    v_exp_f32 v17, v17
    v_exp_f32 v18, v18
    v_exp_f32 v19, v19
    v_exp_f32 v20, v20
    v_exp_f32 v21, v21
    v_exp_f32 v22, v22
    s_mov_b64 exec, s[54:55]
    ds_read_b128 v[76:79], v3 offset:34816
    ds_read_b128 v[80:83], v3 offset:35328
    s_mov_b64 exec, -1
    v_smfmac_f32_32x32x32_bf16 v[44:59], v[68:71], v[12:19], v8
    v_exp_f32 v23, v23
    v_exp_f32 v24, v24
    v_exp_f32 v25, v25
    s_add_u32 m0, s63, 0
    s_add_u32 s8, s67, 131136
    buffer_load_dwordx4 v7, s[32:35], s8 offen lds
    v_mfma_f32_32x32x16_bf16 v[128:143], v[88:91], v[96:99], 0
    v_exp_f32 v26, v26
    v_exp_f32 v27, v27
    v_exp_f32 v28, v28
    v_exp_f32 v29, v29
    s_setprio 2
    s_waitcnt lgkmcnt(0)
    v_smfmac_f32_32x32x32_bf16 v[44:59], v[72:75], v[20:27], v8
    v_exp_f32 v30, v30
    v_exp_f32 v31, v31
    v_exp_f32 v32, v32
    ds_read_b128 v[64:67], v2 offset:38912
    s_waitcnt vmcnt(5)
    ds_read_b64_tr_b16 v[92:93], v9 offset:1024
    ds_read_b64_tr_b16 v[94:95], v9 offset:1280
    v_mfma_f32_32x32x16_bf16 v[12:27], v[60:63], v[84:87], 0
    v_exp_f32 v33, v33
    v_exp_f32 v34, v34
    v_exp_f32 v35, v35
    v_exp_f32 v36, v36
    v_exp_f32 v37, v37
    v_exp_f32 v38, v38
    s_mov_b64 exec, s[54:55]
    ds_read_b128 v[68:71], v3 offset:36864
    ds_read_b128 v[72:75], v3 offset:37376
    s_mov_b64 exec, -1
    v_smfmac_f32_32x32x32_bf16 v[44:59], v[76:79], v[28:35], v8
    v_exp_f32 v39, v39
    v_exp_f32 v40, v40
    v_exp_f32 v41, v41
    s_add_u32 s8, s64, 16384
    buffer_load_dwordx4 v[112:115], v2, s[28:31], s8 offen sc1 nt
    v_mfma_f32_32x32x16_bf16 v[144:159], v[88:91], v[100:103], 0
    v_exp_f32 v42, v42
    v_exp_f32 v43, v43
    v_exp_f32 v12, v12
    v_exp_f32 v13, v13
    s_setprio 1
    s_waitcnt lgkmcnt(0)
    v_smfmac_f32_32x32x32_bf16 v[44:59], v[80:83], v[36:43], v8
    v_exp_f32 v14, v14
    v_exp_f32 v15, v15
    v_exp_f32 v16, v16
    ds_read_b128 v[60:63], v2 offset:40960
    v_mfma_f32_32x32x16_bf16 v[28:43], v[64:67], v[84:87], 0
    v_exp_f32 v17, v17
    v_exp_f32 v18, v18
    v_exp_f32 v19, v19
    v_exp_f32 v20, v20
    v_exp_f32 v21, v21
    v_exp_f32 v22, v22
    s_mov_b64 exec, s[54:55]
    ds_read_b128 v[76:79], v3 offset:38912
    ds_read_b128 v[80:83], v3 offset:39424
    s_mov_b64 exec, -1
    v_smfmac_f32_32x32x32_bf16 v[44:59], v[68:71], v[12:19], v8
    v_exp_f32 v23, v23
    v_exp_f32 v24, v24
    v_exp_f32 v25, v25
    s_add_u32 s8, s64, 104448
    buffer_load_dwordx4 v[116:119], v2, s[28:31], s8 offen sc1 nt
    v_mfma_f32_32x32x16_bf16 v[160:175], v[92:95], v[96:99], 0
    v_exp_f32 v26, v26
    v_exp_f32 v27, v27
    v_exp_f32 v28, v28
    v_exp_f32 v29, v29
    s_setprio 0
    s_waitcnt lgkmcnt(0)
    v_smfmac_f32_32x32x32_bf16 v[44:59], v[72:75], v[20:27], v8
    v_exp_f32 v30, v30
    v_exp_f32 v31, v31
    v_exp_f32 v32, v32
    ds_read_b128 v[64:67], v2 offset:43008
    s_waitcnt vmcnt(3)
    ds_read_b64_tr_b16 v[88:89], v9 offset:2048
    ds_read_b64_tr_b16 v[90:91], v9 offset:2304
    v_mfma_f32_32x32x16_bf16 v[12:27], v[60:63], v[84:87], 0
    v_exp_f32 v33, v33
    v_exp_f32 v34, v34
    v_exp_f32 v35, v35
    v_exp_f32 v36, v36
    v_exp_f32 v37, v37
    v_exp_f32 v38, v38
    s_mov_b64 exec, s[54:55]
    ds_read_b128 v[68:71], v3 offset:40960
    ds_read_b128 v[72:75], v3 offset:41472
    s_mov_b64 exec, -1
    v_smfmac_f32_32x32x32_bf16 v[44:59], v[76:79], v[28:35], v8
    v_exp_f32 v39, v39
    v_exp_f32 v40, v40
    v_exp_f32 v41, v41
    s_add_u32 m0, s63, 1024
    s_add_u32 s8, s67, 262144
    buffer_load_dwordx4 v7, s[32:35], s8 offen lds
    v_mfma_f32_32x32x16_bf16 v[176:191], v[92:95], v[100:103], 0
    v_exp_f32 v42, v42
    v_exp_f32 v43, v43
    v_exp_f32 v12, v12
    v_exp_f32 v13, v13
    s_setprio 3
    s_waitcnt lgkmcnt(0)
    v_smfmac_f32_32x32x32_bf16 v[44:59], v[80:83], v[36:43], v8
    v_exp_f32 v14, v14
    v_exp_f32 v15, v15
    v_exp_f32 v16, v16
    ds_read_b128 v[60:63], v2 offset:45056
    v_mfma_f32_32x32x16_bf16 v[28:43], v[64:67], v[84:87], 0
    v_exp_f32 v17, v17
    v_exp_f32 v18, v18
    v_exp_f32 v19, v19
    v_exp_f32 v20, v20
    v_exp_f32 v21, v21
    v_exp_f32 v22, v22
    s_mov_b64 exec, s[54:55]
    ds_read_b128 v[76:79], v3 offset:43008
    ds_read_b128 v[80:83], v3 offset:43520
    s_mov_b64 exec, -1
    v_smfmac_f32_32x32x32_bf16 v[44:59], v[68:71], v[12:19], v8
    v_exp_f32 v23, v23
    v_exp_f32 v24, v24
    v_exp_f32 v25, v25
    s_add_u32 m0, s63, 2048
    s_add_u32 s8, s67, 262208
    buffer_load_dwordx4 v7, s[32:35], s8 offen lds
    v_mfma_f32_32x32x16_bf16 v[128:143], v[88:91], v[104:107], v[128:143]
    v_exp_f32 v26, v26
    v_exp_f32 v27, v27
    v_exp_f32 v28, v28
    v_exp_f32 v29, v29
    s_setprio 2
    s_waitcnt lgkmcnt(0)
    v_smfmac_f32_32x32x32_bf16 v[44:59], v[72:75], v[20:27], v8
    v_exp_f32 v30, v30
    v_exp_f32 v31, v31
    v_exp_f32 v32, v32
    ds_read_b128 v[64:67], v2 offset:47104
    s_waitcnt vmcnt(4)
    ds_read_b64_tr_b16 v[92:93], v9 offset:0
    ds_read_b64_tr_b16 v[94:95], v9 offset:256
    v_mfma_f32_32x32x16_bf16 v[12:27], v[60:63], v[84:87], 0
    v_exp_f32 v33, v33
    v_exp_f32 v34, v34
    v_exp_f32 v35, v35
    v_exp_f32 v36, v36
    v_exp_f32 v37, v37
    v_exp_f32 v38, v38
    s_mov_b64 exec, s[54:55]
    ds_read_b128 v[68:71], v3 offset:45056
    ds_read_b128 v[72:75], v3 offset:45568
    s_mov_b64 exec, -1
    v_smfmac_f32_32x32x32_bf16 v[44:59], v[76:79], v[28:35], v8
    v_exp_f32 v39, v39
    v_exp_f32 v40, v40
    v_exp_f32 v41, v41
    s_add_u32 s8, s64, 24576
    buffer_load_dwordx4 v[96:99], v2, s[28:31], s8 offen sc1 nt
    v_mfma_f32_32x32x16_bf16 v[144:159], v[88:91], v[108:111], v[144:159]
    v_exp_f32 v42, v42
    v_exp_f32 v43, v43
    v_exp_f32 v12, v12
    v_exp_f32 v13, v13
    s_setprio 1
    s_waitcnt lgkmcnt(0)
    v_smfmac_f32_32x32x32_bf16 v[44:59], v[80:83], v[36:43], v8
    v_exp_f32 v14, v14
    v_exp_f32 v15, v15
    v_exp_f32 v16, v16
    ds_read_b128 v[60:63], v2 offset:49152
    v_mfma_f32_32x32x16_bf16 v[28:43], v[64:67], v[84:87], 0
    v_exp_f32 v17, v17
    v_exp_f32 v18, v18
    v_exp_f32 v19, v19
    v_exp_f32 v20, v20
    v_exp_f32 v21, v21
    v_exp_f32 v22, v22
    s_mov_b64 exec, s[54:55]
    ds_read_b128 v[76:79], v3 offset:47104
    ds_read_b128 v[80:83], v3 offset:47616
    s_mov_b64 exec, -1
    v_smfmac_f32_32x32x32_bf16 v[44:59], v[68:71], v[12:19], v8
    v_exp_f32 v23, v23
    v_exp_f32 v24, v24
    v_exp_f32 v25, v25
    s_add_u32 s8, s64, 112640
    buffer_load_dwordx4 v[100:103], v2, s[28:31], s8 offen sc1 nt
    v_mfma_f32_32x32x16_bf16 v[160:175], v[92:95], v[104:107], v[160:175]
    v_exp_f32 v26, v26
    v_exp_f32 v27, v27
    v_exp_f32 v28, v28
    v_exp_f32 v29, v29
    s_setprio 0
    s_waitcnt lgkmcnt(0)
    v_smfmac_f32_32x32x32_bf16 v[44:59], v[72:75], v[20:27], v8
    v_exp_f32 v30, v30
    v_exp_f32 v31, v31
    v_exp_f32 v32, v32
    ds_read_b128 v[64:67], v2 offset:51200
    s_waitcnt vmcnt(3)
    ds_read_b64_tr_b16 v[88:89], v9 offset:1024
    ds_read_b64_tr_b16 v[90:91], v9 offset:1280
    v_mfma_f32_32x32x16_bf16 v[12:27], v[60:63], v[84:87], 0
    v_exp_f32 v33, v33
    v_exp_f32 v34, v34
    v_exp_f32 v35, v35
    v_exp_f32 v36, v36
    v_exp_f32 v37, v37
    v_exp_f32 v38, v38
    s_mov_b64 exec, s[54:55]
    ds_read_b128 v[68:71], v3 offset:49152
    ds_read_b128 v[72:75], v3 offset:49664
    s_mov_b64 exec, -1
    v_smfmac_f32_32x32x32_bf16 v[44:59], v[76:79], v[28:35], v8
    v_exp_f32 v39, v39
    v_exp_f32 v40, v40
    v_exp_f32 v41, v41
    s_add_u32 m0, s63, 0
    s_add_u32 s8, s67, 393216
    buffer_load_dwordx4 v7, s[32:35], s8 offen lds
    v_mfma_f32_32x32x16_bf16 v[176:191], v[92:95], v[108:111], v[176:191]
    v_exp_f32 v42, v42
    v_exp_f32 v43, v43
    v_exp_f32 v12, v12
    v_exp_f32 v13, v13
    s_setprio 3
    s_waitcnt lgkmcnt(0)
    v_smfmac_f32_32x32x32_bf16 v[44:59], v[80:83], v[36:43], v8
    v_exp_f32 v14, v14
    v_exp_f32 v15, v15
    v_exp_f32 v16, v16
    ds_read_b128 v[60:63], v2 offset:53248
    v_mfma_f32_32x32x16_bf16 v[28:43], v[64:67], v[84:87], 0
    v_exp_f32 v17, v17
    v_exp_f32 v18, v18
    v_exp_f32 v19, v19
    v_exp_f32 v20, v20
    v_exp_f32 v21, v21
    v_exp_f32 v22, v22
    s_mov_b64 exec, s[54:55]
    ds_read_b128 v[76:79], v3 offset:51200
    ds_read_b128 v[80:83], v3 offset:51712
    s_mov_b64 exec, -1
    v_smfmac_f32_32x32x32_bf16 v[44:59], v[68:71], v[12:19], v8
    v_exp_f32 v23, v23
    v_exp_f32 v24, v24
    v_exp_f32 v25, v25
    s_add_u32 m0, s63, 1024
    s_add_u32 s8, s67, 393280
    buffer_load_dwordx4 v7, s[32:35], s8 offen lds
    v_mfma_f32_32x32x16_bf16 v[128:143], v[88:91], v[112:115], v[128:143]
    v_exp_f32 v26, v26
    v_exp_f32 v27, v27
    v_exp_f32 v28, v28
    v_exp_f32 v29, v29
    s_setprio 2
    s_waitcnt lgkmcnt(0)
    v_smfmac_f32_32x32x32_bf16 v[44:59], v[72:75], v[20:27], v8
    v_exp_f32 v30, v30
    v_exp_f32 v31, v31
    v_exp_f32 v32, v32
    ds_read_b128 v[64:67], v2 offset:55296
    s_waitcnt vmcnt(4)
    ds_read_b64_tr_b16 v[92:93], v9 offset:2048
    ds_read_b64_tr_b16 v[94:95], v9 offset:2304
    v_mfma_f32_32x32x16_bf16 v[12:27], v[60:63], v[84:87], 0
    v_exp_f32 v33, v33
    v_exp_f32 v34, v34
    v_exp_f32 v35, v35
    v_exp_f32 v36, v36
    v_exp_f32 v37, v37
    v_exp_f32 v38, v38
    s_mov_b64 exec, s[54:55]
    ds_read_b128 v[68:71], v3 offset:53248
    ds_read_b128 v[72:75], v3 offset:53760
    s_mov_b64 exec, -1
    v_smfmac_f32_32x32x32_bf16 v[44:59], v[76:79], v[28:35], v8
    v_exp_f32 v39, v39
    v_exp_f32 v40, v40
    v_exp_f32 v41, v41
    s_add_u32 s8, s64, 32768
    buffer_load_dwordx4 v[104:107], v2, s[28:31], s8 offen sc1 nt
    v_mfma_f32_32x32x16_bf16 v[144:159], v[88:91], v[116:119], v[144:159]
    v_exp_f32 v42, v42
    v_exp_f32 v43, v43
    v_exp_f32 v12, v12
    v_exp_f32 v13, v13
    s_setprio 1
    s_waitcnt lgkmcnt(0)
    v_smfmac_f32_32x32x32_bf16 v[44:59], v[80:83], v[36:43], v8
    v_exp_f32 v14, v14
    v_exp_f32 v15, v15
    v_exp_f32 v16, v16
    ds_read_b128 v[60:63], v2 offset:57344
    v_mfma_f32_32x32x16_bf16 v[28:43], v[64:67], v[84:87], 0
    v_exp_f32 v17, v17
    v_exp_f32 v18, v18
    v_exp_f32 v19, v19
    v_exp_f32 v20, v20
    v_exp_f32 v21, v21
    v_exp_f32 v22, v22
    s_mov_b64 exec, s[54:55]
    ds_read_b128 v[76:79], v3 offset:55296
    ds_read_b128 v[80:83], v3 offset:55808
    s_mov_b64 exec, -1
    v_smfmac_f32_32x32x32_bf16 v[44:59], v[68:71], v[12:19], v8
    v_exp_f32 v23, v23
    v_exp_f32 v24, v24
    v_exp_f32 v25, v25
    s_add_u32 s8, s64, 120832
    buffer_load_dwordx4 v[108:111], v2, s[28:31], s8 offen sc1 nt
    v_mfma_f32_32x32x16_bf16 v[160:175], v[92:95], v[112:115], v[160:175]
    v_exp_f32 v26, v26
    v_exp_f32 v27, v27
    v_exp_f32 v28, v28
    v_exp_f32 v29, v29
    s_setprio 0
    s_waitcnt lgkmcnt(0)
    v_smfmac_f32_32x32x32_bf16 v[44:59], v[72:75], v[20:27], v8
    v_exp_f32 v30, v30
    v_exp_f32 v31, v31
    v_exp_f32 v32, v32
    ds_read_b128 v[64:67], v2 offset:59392
    s_waitcnt vmcnt(3)
    ds_read_b64_tr_b16 v[88:89], v9 offset:0
    ds_read_b64_tr_b16 v[90:91], v9 offset:256
    v_mfma_f32_32x32x16_bf16 v[12:27], v[60:63], v[84:87], 0
    v_exp_f32 v33, v33
    v_exp_f32 v34, v34
    v_exp_f32 v35, v35
    v_exp_f32 v36, v36
    v_exp_f32 v37, v37
    v_exp_f32 v38, v38
    s_mov_b64 exec, s[54:55]
    ds_read_b128 v[68:71], v3 offset:57344
    ds_read_b128 v[72:75], v3 offset:57856
    s_mov_b64 exec, -1
    v_smfmac_f32_32x32x32_bf16 v[44:59], v[76:79], v[28:35], v8
    v_exp_f32 v39, v39
    v_exp_f32 v40, v40
    v_exp_f32 v41, v41
    s_add_u32 m0, s63, 2048
    s_add_u32 s8, s67, 524288
    buffer_load_dwordx4 v7, s[32:35], s8 offen lds
    v_mfma_f32_32x32x16_bf16 v[176:191], v[92:95], v[116:119], v[176:191]
    v_exp_f32 v42, v42
    v_exp_f32 v43, v43
    v_exp_f32 v12, v12
    v_exp_f32 v13, v13
    s_setprio 3
    s_waitcnt lgkmcnt(0)
    v_smfmac_f32_32x32x32_bf16 v[44:59], v[80:83], v[36:43], v8
    v_exp_f32 v14, v14
    v_exp_f32 v15, v15
    v_exp_f32 v16, v16
    ds_read_b128 v[60:63], v2 offset:61440
    v_mfma_f32_32x32x16_bf16 v[28:43], v[64:67], v[84:87], 0
    v_exp_f32 v17, v17
    v_exp_f32 v18, v18
    v_exp_f32 v19, v19
    v_exp_f32 v20, v20
    v_exp_f32 v21, v21
    v_exp_f32 v22, v22
    s_mov_b64 exec, s[54:55]
    ds_read_b128 v[76:79], v3 offset:59392
    ds_read_b128 v[80:83], v3 offset:59904
    s_mov_b64 exec, -1
    v_smfmac_f32_32x32x32_bf16 v[44:59], v[68:71], v[12:19], v8
    v_exp_f32 v23, v23
    v_exp_f32 v24, v24
    v_exp_f32 v25, v25
    s_add_u32 m0, s63, 0
    s_add_u32 s8, s67, 524352
    buffer_load_dwordx4 v7, s[32:35], s8 offen lds
    v_mfma_f32_32x32x16_bf16 v[128:143], v[88:91], v[96:99], v[128:143]
    v_exp_f32 v26, v26
    v_exp_f32 v27, v27
    v_exp_f32 v28, v28
    v_exp_f32 v29, v29
    s_setprio 2
    s_waitcnt lgkmcnt(0)
    v_smfmac_f32_32x32x32_bf16 v[44:59], v[72:75], v[20:27], v8
    v_exp_f32 v30, v30
    v_exp_f32 v31, v31
    v_exp_f32 v32, v32
    ds_read_b128 v[64:67], v2 offset:63488
    s_waitcnt vmcnt(4)
    ds_read_b64_tr_b16 v[92:93], v9 offset:1024
    ds_read_b64_tr_b16 v[94:95], v9 offset:1280
    v_mfma_f32_32x32x16_bf16 v[12:27], v[60:63], v[84:87], 0
    v_exp_f32 v33, v33
    v_exp_f32 v34, v34
    v_exp_f32 v35, v35
    v_exp_f32 v36, v36
    v_exp_f32 v37, v37
    v_exp_f32 v38, v38
    s_mov_b64 exec, s[54:55]
    ds_read_b128 v[68:71], v3 offset:61440
    ds_read_b128 v[72:75], v3 offset:61952
    s_mov_b64 exec, -1
    v_smfmac_f32_32x32x32_bf16 v[44:59], v[76:79], v[28:35], v8
    v_exp_f32 v39, v39
    v_exp_f32 v40, v40
    v_exp_f32 v41, v41
    s_add_u32 s8, s64, 40960
    buffer_load_dwordx4 v[112:115], v2, s[28:31], s8 offen sc1
    v_mfma_f32_32x32x16_bf16 v[144:159], v[88:91], v[100:103], v[144:159]
    v_exp_f32 v42, v42
    v_exp_f32 v43, v43
    v_exp_f32 v12, v12
    v_exp_f32 v13, v13
    s_setprio 1
    s_waitcnt lgkmcnt(0)
    v_smfmac_f32_32x32x32_bf16 v[44:59], v[80:83], v[36:43], v8
    v_exp_f32 v14, v14
    v_exp_f32 v15, v15
    v_exp_f32 v16, v16
    ds_read_b128 v[60:63], v4 offset:0
    v_mfma_f32_32x32x16_bf16 v[28:43], v[64:67], v[84:87], 0
    v_exp_f32 v17, v17
    v_exp_f32 v18, v18
    v_exp_f32 v19, v19
    v_exp_f32 v20, v20
    v_exp_f32 v21, v21
    v_exp_f32 v22, v22
    s_mov_b64 exec, s[54:55]
    ds_read_b128 v[76:79], v3 offset:63488
    ds_read_b128 v[80:83], v3 offset:64000
    s_mov_b64 exec, -1
    v_smfmac_f32_32x32x32_bf16 v[44:59], v[68:71], v[12:19], v8
    v_exp_f32 v23, v23
    v_exp_f32 v24, v24
    v_exp_f32 v25, v25
    s_add_u32 s8, s64, 129024
    buffer_load_dwordx4 v[116:119], v2, s[28:31], s8 offen sc1
    v_mfma_f32_32x32x16_bf16 v[160:175], v[92:95], v[96:99], v[160:175]
    v_exp_f32 v26, v26
    v_exp_f32 v27, v27
    v_exp_f32 v28, v28
    v_exp_f32 v29, v29
    s_setprio 0
    s_waitcnt lgkmcnt(0)
    v_smfmac_f32_32x32x32_bf16 v[44:59], v[72:75], v[20:27], v8
    v_exp_f32 v30, v30
    v_exp_f32 v31, v31
    v_exp_f32 v32, v32
    ds_read_b128 v[64:67], v4 offset:2048
    s_waitcnt vmcnt(3)
    ds_read_b64_tr_b16 v[88:89], v9 offset:2048
    ds_read_b64_tr_b16 v[90:91], v9 offset:2304
    v_mfma_f32_32x32x16_bf16 v[12:27], v[60:63], v[84:87], 0
    v_exp_f32 v33, v33
    v_exp_f32 v34, v34
    v_exp_f32 v35, v35
    v_exp_f32 v36, v36
    v_exp_f32 v37, v37
    v_exp_f32 v38, v38
    s_mov_b64 exec, s[54:55]
    ds_read_b128 v[68:71], v5 offset:0
    ds_read_b128 v[72:75], v5 offset:512
    s_mov_b64 exec, -1
    v_smfmac_f32_32x32x32_bf16 v[44:59], v[76:79], v[28:35], v8
    v_exp_f32 v39, v39
    v_exp_f32 v40, v40
    v_exp_f32 v41, v41
    s_add_u32 m0, s63, 1024
    s_add_u32 s8, s67, 655360
    buffer_load_dwordx4 v7, s[32:35], s8 offen lds
    v_mfma_f32_32x32x16_bf16 v[176:191], v[92:95], v[100:103], v[176:191]
    v_exp_f32 v42, v42
    v_exp_f32 v43, v43
    v_exp_f32 v12, v12
    v_exp_f32 v13, v13
    s_setprio 3
    s_waitcnt lgkmcnt(0)
    v_smfmac_f32_32x32x32_bf16 v[44:59], v[80:83], v[36:43], v8
    v_exp_f32 v14, v14
    v_exp_f32 v15, v15
    v_exp_f32 v16, v16
    ds_read_b128 v[60:63], v4 offset:4096
    v_mfma_f32_32x32x16_bf16 v[28:43], v[64:67], v[84:87], 0
    v_exp_f32 v17, v17
    v_exp_f32 v18, v18
    v_exp_f32 v19, v19
    v_exp_f32 v20, v20
    v_exp_f32 v21, v21
    v_exp_f32 v22, v22
    s_mov_b64 exec, s[54:55]
    ds_read_b128 v[76:79], v5 offset:2048
    ds_read_b128 v[80:83], v5 offset:2560
    s_mov_b64 exec, -1
    v_smfmac_f32_32x32x32_bf16 v[44:59], v[68:71], v[12:19], v8
    v_exp_f32 v23, v23
    v_exp_f32 v24, v24
    v_exp_f32 v25, v25
    s_add_u32 m0, s63, 2048
    s_add_u32 s8, s67, 655424
    buffer_load_dwordx4 v7, s[32:35], s8 offen lds
    v_mfma_f32_32x32x16_bf16 v[128:143], v[88:91], v[104:107], v[128:143]
    v_exp_f32 v26, v26
    v_exp_f32 v27, v27
    v_exp_f32 v28, v28
    v_exp_f32 v29, v29
    s_setprio 2
    s_waitcnt lgkmcnt(0)
    v_smfmac_f32_32x32x32_bf16 v[44:59], v[72:75], v[20:27], v8
    v_exp_f32 v30, v30
    v_exp_f32 v31, v31
    v_exp_f32 v32, v32
    ds_read_b128 v[64:67], v4 offset:6144
    s_waitcnt vmcnt(4)
    ds_read_b64_tr_b16 v[92:93], v9 offset:0
    ds_read_b64_tr_b16 v[94:95], v9 offset:256
    v_mfma_f32_32x32x16_bf16 v[12:27], v[60:63], v[84:87], 0
    v_exp_f32 v33, v33
    v_exp_f32 v34, v34
    v_exp_f32 v35, v35
    v_exp_f32 v36, v36
    v_exp_f32 v37, v37
    v_exp_f32 v38, v38
    s_mov_b64 exec, s[54:55]
    ds_read_b128 v[68:71], v5 offset:4096
    ds_read_b128 v[72:75], v5 offset:4608
    s_mov_b64 exec, -1
    v_smfmac_f32_32x32x32_bf16 v[44:59], v[76:79], v[28:35], v8
    v_exp_f32 v39, v39
    v_exp_f32 v40, v40
    v_exp_f32 v41, v41
    s_add_u32 s8, s64, 49152
    buffer_load_dwordx4 v[96:99], v2, s[28:31], s8 offen sc1
    v_mfma_f32_32x32x16_bf16 v[144:159], v[88:91], v[108:111], v[144:159]
    v_exp_f32 v42, v42
    v_exp_f32 v43, v43
    v_exp_f32 v12, v12
    v_exp_f32 v13, v13
    s_setprio 3
    s_cmp_eq_u32 s7, 0
    s_cbranch_scc1 Lstg_6
    s_setprio 1
Lstg_6:
    s_waitcnt lgkmcnt(0)
    v_smfmac_f32_32x32x32_bf16 v[44:59], v[80:83], v[36:43], v8
    v_exp_f32 v14, v14
    v_exp_f32 v15, v15
    v_exp_f32 v16, v16
    ds_read_b128 v[60:63], v4 offset:8192
    v_mfma_f32_32x32x16_bf16 v[28:43], v[64:67], v[84:87], 0
    v_exp_f32 v17, v17
    v_exp_f32 v18, v18
    v_exp_f32 v19, v19
    v_exp_f32 v20, v20
    v_exp_f32 v21, v21
    v_exp_f32 v22, v22
    s_mov_b64 exec, s[54:55]
    ds_read_b128 v[76:79], v5 offset:6144
    ds_read_b128 v[80:83], v5 offset:6656
    s_mov_b64 exec, -1
    v_smfmac_f32_32x32x32_bf16 v[44:59], v[68:71], v[12:19], v8
    v_exp_f32 v23, v23
    v_exp_f32 v24, v24
    v_exp_f32 v25, v25
    s_add_u32 s8, s64, 137216
    buffer_load_dwordx4 v[100:103], v2, s[28:31], s8 offen sc1
    v_mfma_f32_32x32x16_bf16 v[160:175], v[92:95], v[104:107], v[160:175]
    v_exp_f32 v26, v26
    v_exp_f32 v27, v27
    v_exp_f32 v28, v28
    v_exp_f32 v29, v29
    s_waitcnt lgkmcnt(0)
    v_smfmac_f32_32x32x32_bf16 v[44:59], v[72:75], v[20:27], v8
    v_exp_f32 v30, v30
    v_exp_f32 v31, v31
    v_exp_f32 v32, v32
    ds_read_b128 v[64:67], v4 offset:10240
    s_waitcnt vmcnt(3)
    ds_read_b64_tr_b16 v[88:89], v9 offset:1024
    ds_read_b64_tr_b16 v[90:91], v9 offset:1280
    v_mfma_f32_32x32x16_bf16 v[12:27], v[60:63], v[84:87], 0
    v_exp_f32 v33, v33
    v_exp_f32 v34, v34
    v_exp_f32 v35, v35
    v_exp_f32 v36, v36
    v_exp_f32 v37, v37
    v_exp_f32 v38, v38
    s_mov_b64 exec, s[54:55]
    ds_read_b128 v[68:71], v5 offset:8192
    ds_read_b128 v[72:75], v5 offset:8704
    s_mov_b64 exec, -1
    v_smfmac_f32_32x32x32_bf16 v[44:59], v[76:79], v[28:35], v8
    v_exp_f32 v39, v39
    v_exp_f32 v40, v40
    v_exp_f32 v41, v41
    s_add_u32 m0, s63, 0
    s_add_u32 s8, s67, 786432
    buffer_load_dwordx4 v7, s[32:35], s8 offen lds
    v_mfma_f32_32x32x16_bf16 v[176:191], v[92:95], v[108:111], v[176:191]
    v_exp_f32 v42, v42
    v_exp_f32 v43, v43
    v_exp_f32 v12, v12
    v_exp_f32 v13, v13
    s_waitcnt lgkmcnt(0)
    v_smfmac_f32_32x32x32_bf16 v[44:59], v[80:83], v[36:43], v8
    v_exp_f32 v14, v14
    v_exp_f32 v15, v15
    v_exp_f32 v16, v16
    ds_read_b128 v[60:63], v4 offset:12288
    v_mfma_f32_32x32x16_bf16 v[28:43], v[64:67], v[84:87], 0
    v_exp_f32 v17, v17
    v_exp_f32 v18, v18
    v_exp_f32 v19, v19
    v_exp_f32 v20, v20
    v_exp_f32 v21, v21
    v_exp_f32 v22, v22
    s_mov_b64 exec, s[54:55]
    ds_read_b128 v[76:79], v5 offset:10240
    ds_read_b128 v[80:83], v5 offset:10752
    s_mov_b64 exec, -1
    v_smfmac_f32_32x32x32_bf16 v[44:59], v[68:71], v[12:19], v8
    v_exp_f32 v23, v23
    v_exp_f32 v24, v24
    v_exp_f32 v25, v25
    s_add_u32 m0, s63, 1024
    s_add_u32 s8, s67, 786496
    buffer_load_dwordx4 v7, s[32:35], s8 offen lds
    v_mfma_f32_32x32x16_bf16 v[128:143], v[88:91], v[112:115], v[128:143]
    v_exp_f32 v26, v26
    v_exp_f32 v27, v27
    v_exp_f32 v28, v28
    v_exp_f32 v29, v29
    s_waitcnt lgkmcnt(0)
    v_smfmac_f32_32x32x32_bf16 v[44:59], v[72:75], v[20:27], v8
    v_exp_f32 v30, v30
    v_exp_f32 v31, v31
    v_exp_f32 v32, v32
    ds_read_b128 v[64:67], v4 offset:14336
    s_waitcnt vmcnt(4)
    ds_read_b64_tr_b16 v[92:93], v9 offset:2048
    ds_read_b64_tr_b16 v[94:95], v9 offset:2304
    v_mfma_f32_32x32x16_bf16 v[12:27], v[60:63], v[84:87], 0
    v_exp_f32 v33, v33
    v_exp_f32 v34, v34
    v_exp_f32 v35, v35
    v_exp_f32 v36, v36
    v_exp_f32 v37, v37
    v_exp_f32 v38, v38
    s_mov_b64 exec, s[54:55]
    ds_read_b128 v[68:71], v5 offset:12288
    ds_read_b128 v[72:75], v5 offset:12800
    s_mov_b64 exec, -1
    v_smfmac_f32_32x32x32_bf16 v[44:59], v[76:79], v[28:35], v8
    v_exp_f32 v39, v39
    v_exp_f32 v40, v40
    v_exp_f32 v41, v41
    s_add_u32 s8, s64, 57344
    buffer_load_dwordx4 v[104:107], v2, s[28:31], s8 offen sc1
    v_mfma_f32_32x32x16_bf16 v[144:159], v[88:91], v[116:119], v[144:159]
    v_exp_f32 v42, v42
    v_exp_f32 v43, v43
    v_exp_f32 v12, v12
    v_exp_f32 v13, v13
    s_waitcnt lgkmcnt(0)
    v_smfmac_f32_32x32x32_bf16 v[44:59], v[80:83], v[36:43], v8
    v_exp_f32 v14, v14
    v_exp_f32 v15, v15
    v_exp_f32 v16, v16
    ds_read_b128 v[60:63], v4 offset:16384
    v_mfma_f32_32x32x16_bf16 v[28:43], v[64:67], v[84:87], 0
    v_exp_f32 v17, v17
    v_exp_f32 v18, v18
    v_exp_f32 v19, v19
    v_exp_f32 v20, v20
    v_exp_f32 v21, v21
    v_exp_f32 v22, v22
    s_mov_b64 exec, s[54:55]
    ds_read_b128 v[76:79], v5 offset:14336
    ds_read_b128 v[80:83], v5 offset:14848
    s_mov_b64 exec, -1
    v_smfmac_f32_32x32x32_bf16 v[44:59], v[68:71], v[12:19], v8
    v_exp_f32 v23, v23
    v_exp_f32 v24, v24
    v_exp_f32 v25, v25
    s_add_u32 s8, s64, 145408
    buffer_load_dwordx4 v[108:111], v2, s[28:31], s8 offen sc1
    v_mfma_f32_32x32x16_bf16 v[160:175], v[92:95], v[112:115], v[160:175]
    v_exp_f32 v26, v26
    v_exp_f32 v27, v27
    v_exp_f32 v28, v28
    v_exp_f32 v29, v29
    s_waitcnt lgkmcnt(0)
    v_smfmac_f32_32x32x32_bf16 v[44:59], v[72:75], v[20:27], v8
    v_exp_f32 v30, v30
    v_exp_f32 v31, v31
    v_exp_f32 v32, v32
    ds_read_b128 v[64:67], v4 offset:18432
    s_waitcnt vmcnt(3)
    ds_read_b64_tr_b16 v[88:89], v9 offset:0
    ds_read_b64_tr_b16 v[90:91], v9 offset:256
    v_mfma_f32_32x32x16_bf16 v[12:27], v[60:63], v[84:87], 0
    v_exp_f32 v33, v33
    v_exp_f32 v34, v34
    v_exp_f32 v35, v35
    v_exp_f32 v36, v36
    v_exp_f32 v37, v37
    v_exp_f32 v38, v38
    s_mov_b64 exec, s[54:55]
    ds_read_b128 v[68:71], v5 offset:16384
    ds_read_b128 v[72:75], v5 offset:16896
    s_mov_b64 exec, -1
    v_smfmac_f32_32x32x32_bf16 v[44:59], v[76:79], v[28:35], v8
    v_exp_f32 v39, v39
    v_exp_f32 v40, v40
    v_exp_f32 v41, v41
    s_add_u32 m0, s63, 2048
    s_add_u32 s8, s67, 917504
    buffer_load_dwordx4 v7, s[32:35], s8 offen lds
    v_mfma_f32_32x32x16_bf16 v[176:191], v[92:95], v[116:119], v[176:191]
    v_exp_f32 v42, v42
    v_exp_f32 v43, v43
    v_exp_f32 v12, v12
    v_exp_f32 v13, v13
    s_waitcnt lgkmcnt(0)
    v_smfmac_f32_32x32x32_bf16 v[44:59], v[80:83], v[36:43], v8
    v_exp_f32 v14, v14
    v_exp_f32 v15, v15
    v_exp_f32 v16, v16
    ds_read_b128 v[60:63], v4 offset:20480
    v_mfma_f32_32x32x16_bf16 v[28:43], v[64:67], v[84:87], 0
    v_exp_f32 v17, v17
    v_exp_f32 v18, v18
    v_exp_f32 v19, v19
    v_exp_f32 v20, v20
    v_exp_f32 v21, v21
    v_exp_f32 v22, v22
    s_mov_b64 exec, s[54:55]
    ds_read_b128 v[76:79], v5 offset:18432
    ds_read_b128 v[80:83], v5 offset:18944
    s_mov_b64 exec, -1
    v_smfmac_f32_32x32x32_bf16 v[44:59], v[68:71], v[12:19], v8
    v_exp_f32 v23, v23
    v_exp_f32 v24, v24
    v_exp_f32 v25, v25
    s_add_u32 m0, s63, 0
    s_add_u32 s8, s67, 917568
    buffer_load_dwordx4 v7, s[32:35], s8 offen lds
    v_mfma_f32_32x32x16_bf16 v[128:143], v[88:91], v[96:99], v[128:143]
    v_exp_f32 v26, v26
    v_exp_f32 v27, v27
    v_exp_f32 v28, v28
    v_exp_f32 v29, v29
    s_waitcnt lgkmcnt(0)
    v_smfmac_f32_32x32x32_bf16 v[44:59], v[72:75], v[20:27], v8
    v_exp_f32 v30, v30
    v_exp_f32 v31, v31
    v_exp_f32 v32, v32
    ds_read_b128 v[64:67], v4 offset:22528
    s_waitcnt vmcnt(4)
    ds_read_b64_tr_b16 v[92:93], v9 offset:1024
    ds_read_b64_tr_b16 v[94:95], v9 offset:1280
    v_mfma_f32_32x32x16_bf16 v[12:27], v[60:63], v[84:87], 0
    v_exp_f32 v33, v33
    v_exp_f32 v34, v34
    v_exp_f32 v35, v35
    v_exp_f32 v36, v36
    v_exp_f32 v37, v37
    v_exp_f32 v38, v38
    s_mov_b64 exec, s[54:55]
    ds_read_b128 v[68:71], v5 offset:20480
    ds_read_b128 v[72:75], v5 offset:20992
    s_mov_b64 exec, -1
    v_smfmac_f32_32x32x32_bf16 v[44:59], v[76:79], v[28:35], v8
    v_exp_f32 v39, v39
    v_exp_f32 v40, v40
    v_exp_f32 v41, v41
    s_add_u32 s8, s64, 65536
    buffer_load_dwordx4 v[112:115], v2, s[28:31], s8 offen sc1
    v_mfma_f32_32x32x16_bf16 v[144:159], v[88:91], v[100:103], v[144:159]
    v_exp_f32 v42, v42
    v_exp_f32 v43, v43
    v_exp_f32 v12, v12
    v_exp_f32 v13, v13
    s_waitcnt lgkmcnt(0)
    v_smfmac_f32_32x32x32_bf16 v[44:59], v[80:83], v[36:43], v8
    v_exp_f32 v14, v14
    v_exp_f32 v15, v15
    v_exp_f32 v16, v16
    ds_read_b128 v[60:63], v4 offset:24576
    v_mfma_f32_32x32x16_bf16 v[28:43], v[64:67], v[84:87], 0
    v_exp_f32 v17, v17
    v_exp_f32 v18, v18
    v_exp_f32 v19, v19
    v_exp_f32 v20, v20
    v_exp_f32 v21, v21
    v_exp_f32 v22, v22
    s_mov_b64 exec, s[54:55]
    ds_read_b128 v[76:79], v5 offset:22528
    ds_read_b128 v[80:83], v5 offset:23040
    s_mov_b64 exec, -1
    v_smfmac_f32_32x32x32_bf16 v[44:59], v[68:71], v[12:19], v8
    v_exp_f32 v23, v23
    v_exp_f32 v24, v24
    v_exp_f32 v25, v25
    s_add_u32 s8, s64, 153600
    buffer_load_dwordx4 v[116:119], v2, s[28:31], s8 offen sc1
    v_mfma_f32_32x32x16_bf16 v[160:175], v[92:95], v[96:99], v[160:175]
    v_exp_f32 v26, v26
    v_exp_f32 v27, v27
    v_exp_f32 v28, v28
    v_exp_f32 v29, v29
    s_waitcnt lgkmcnt(0)
    v_smfmac_f32_32x32x32_bf16 v[44:59], v[72:75], v[20:27], v8
    v_exp_f32 v30, v30
    v_exp_f32 v31, v31
    v_exp_f32 v32, v32
    ds_read_b128 v[64:67], v4 offset:26624
    s_waitcnt vmcnt(3)
    ds_read_b64_tr_b16 v[88:89], v9 offset:2048
    ds_read_b64_tr_b16 v[90:91], v9 offset:2304
    v_mfma_f32_32x32x16_bf16 v[12:27], v[60:63], v[84:87], 0
    v_exp_f32 v33, v33
    v_exp_f32 v34, v34
    v_exp_f32 v35, v35
    v_exp_f32 v36, v36
    v_exp_f32 v37, v37
    v_exp_f32 v38, v38
    s_mov_b64 exec, s[54:55]
    ds_read_b128 v[68:71], v5 offset:24576
    ds_read_b128 v[72:75], v5 offset:25088
    s_mov_b64 exec, -1
    v_smfmac_f32_32x32x32_bf16 v[44:59], v[76:79], v[28:35], v8
    v_exp_f32 v39, v39
    v_exp_f32 v40, v40
    v_exp_f32 v41, v41
    s_add_u32 s8, s64, 81920
    s_add_u32 s8, s8, s71
    buffer_load_dwordx4 v[248:251], v2, s[28:31], s8 offen sc1
    v_mfma_f32_32x32x16_bf16 v[176:191], v[92:95], v[100:103], v[176:191]
    v_exp_f32 v42, v42
    v_exp_f32 v43, v43
    v_exp_f32 v12, v12
    v_exp_f32 v13, v13
    s_waitcnt lgkmcnt(0)
    v_smfmac_f32_32x32x32_bf16 v[44:59], v[80:83], v[36:43], v8
    v_exp_f32 v14, v14
    v_exp_f32 v15, v15
    v_exp_f32 v16, v16
    ds_read_b128 v[60:63], v4 offset:28672
    v_mfma_f32_32x32x16_bf16 v[28:43], v[64:67], v[84:87], 0
    v_exp_f32 v17, v17
    v_exp_f32 v18, v18
    v_exp_f32 v19, v19
    v_exp_f32 v20, v20
    v_exp_f32 v21, v21
    v_exp_f32 v22, v22
    s_mov_b64 exec, s[54:55]
    ds_read_b128 v[76:79], v5 offset:26624
    ds_read_b128 v[80:83], v5 offset:27136
    s_mov_b64 exec, -1
    v_smfmac_f32_32x32x32_bf16 v[44:59], v[68:71], v[12:19], v8
    v_exp_f32 v23, v23
    v_exp_f32 v24, v24
    v_exp_f32 v25, v25
    s_add_u32 s8, s64, 169984
    s_add_u32 s8, s8, s71
    buffer_load_dwordx4 v[252:255], v2, s[28:31], s8 offen sc1
    v_mfma_f32_32x32x16_bf16 v[128:143], v[88:91], v[104:107], v[128:143]
    v_exp_f32 v26, v26
    v_exp_f32 v27, v27
    v_exp_f32 v28, v28
    v_exp_f32 v29, v29
    s_waitcnt lgkmcnt(0)
    v_smfmac_f32_32x32x32_bf16 v[44:59], v[72:75], v[20:27], v8
    v_exp_f32 v30, v30
    v_exp_f32 v31, v31
    v_exp_f32 v32, v32
    ds_read_b128 v[64:67], v4 offset:30720
    s_waitcnt vmcnt(4)
    ds_read_b64_tr_b16 v[92:93], v9 offset:0
    ds_read_b64_tr_b16 v[94:95], v9 offset:256
    v_mfma_f32_32x32x16_bf16 v[12:27], v[60:63], v[84:87], 0
    v_exp_f32 v33, v33
    v_exp_f32 v34, v34
    v_exp_f32 v35, v35
    v_exp_f32 v36, v36
    v_exp_f32 v37, v37
    v_exp_f32 v38, v38
    s_mov_b64 exec, s[54:55]
    ds_read_b128 v[68:71], v5 offset:28672
    ds_read_b128 v[72:75], v5 offset:29184
    s_mov_b64 exec, -1
    v_smfmac_f32_32x32x32_bf16 v[44:59], v[76:79], v[28:35], v8
    v_exp_f32 v39, v39
    v_exp_f32 v40, v40
    v_exp_f32 v41, v41
    s_add_u32 s8, s64, 73728
    buffer_load_dwordx4 v[96:99], v2, s[28:31], s8 offen sc1
    v_mfma_f32_32x32x16_bf16 v[144:159], v[88:91], v[108:111], v[144:159]
    v_exp_f32 v42, v42
    v_exp_f32 v43, v43
    v_exp_f32 v12, v12
    v_exp_f32 v13, v13
    s_waitcnt lgkmcnt(0)
    v_smfmac_f32_32x32x32_bf16 v[44:59], v[80:83], v[36:43], v8
    v_exp_f32 v14, v14
    v_exp_f32 v15, v15
    v_exp_f32 v16, v16
    v_mfma_f32_32x32x16_bf16 v[28:43], v[64:67], v[84:87], 0
    v_exp_f32 v17, v17
    v_exp_f32 v18, v18
    v_exp_f32 v19, v19
    v_exp_f32 v20, v20
    v_exp_f32 v21, v21
    v_exp_f32 v22, v22
    s_mov_b64 exec, s[54:55]
    ds_read_b128 v[76:79], v5 offset:30720
    ds_read_b128 v[80:83], v5 offset:31232
    s_mov_b64 exec, -1
    v_smfmac_f32_32x32x32_bf16 v[44:59], v[68:71], v[12:19], v8
    v_exp_f32 v23, v23
    v_exp_f32 v24, v24
    v_exp_f32 v25, v25
    s_add_u32 s8, s64, 161792
    buffer_load_dwordx4 v[100:103], v2, s[28:31], s8 offen sc1
    v_mfma_f32_32x32x16_bf16 v[160:175], v[92:95], v[104:107], v[160:175]
    v_exp_f32 v26, v26
    v_exp_f32 v27, v27
    v_exp_f32 v28, v28
    v_exp_f32 v29, v29
    s_waitcnt lgkmcnt(0)
    v_smfmac_f32_32x32x32_bf16 v[44:59], v[72:75], v[20:27], v8
    v_exp_f32 v30, v30
    v_exp_f32 v31, v31
    v_exp_f32 v32, v32
    v_exp_f32 v33, v33
    v_exp_f32 v34, v34
    v_exp_f32 v35, v35
    v_exp_f32 v36, v36
    v_exp_f32 v37, v37
    v_exp_f32 v38, v38
    v_smfmac_f32_32x32x32_bf16 v[44:59], v[76:79], v[28:35], v8
    v_exp_f32 v39, v39
    v_exp_f32 v40, v40
    v_exp_f32 v41, v41
    v_mfma_f32_32x32x16_bf16 v[176:191], v[92:95], v[108:111], v[176:191]
    v_exp_f32 v42, v42
    v_exp_f32 v43, v43
    s_setprio 3
    s_nop 0
    v_smfmac_f32_32x32x32_bf16 v[44:59], v[80:83], v[36:43], v8
    s_mov_b32 s8, 0x5f800000
    s_lshl_b32 s67, s56, 16
    s_lshl_b32 s9, s76, 12
    s_add_u32 s9, s9, 12582912
    s_add_u32 s64, s67, s9
    s_add_u32 s66, s64, 0x8000
    s_nop 5
    v_fma_f32 v122, v44, 0, v52
    v_fma_f32 v122, v45, 0, v122
    v_fma_f32 v122, v46, 0, v122
    v_fma_f32 v122, v47, 0, v122
    v_fma_f32 v122, v48, 0, v122
    v_fma_f32 v122, v49, 0, v122
    v_fma_f32 v122, v50, 0, v122
    v_fma_f32 v122, v51, 0, v122
    v_cmp_nle_f32 vcc, 1.0, v122
    v_cmp_nge_f32 s[10:11], s8, v122
    s_or_b64 vcc, vcc, s[10:11]
    s_cbranch_vccnz L_fallback
L_fbdone:
    v_rcp_f32 v122, v52
    s_nop 0
    v_mul_f32 v122, v122, v10
    v_mul_f32 v44, v44, v122
    v_mul_f32 v45, v45, v122
    v_mul_f32 v46, v46, v122
    v_mul_f32 v47, v47, v122
    v_mul_f32 v48, v48, v122
    v_mul_f32 v49, v49, v122
    v_mul_f32 v50, v50, v122
    v_mul_f32 v51, v51, v122
    v_cvt_pk_bf16_f32 v60, v44, v45
    v_cvt_pk_bf16_f32 v61, v46, v47
    v_cvt_pk_bf16_f32 v62, v48, v49
    v_cvt_pk_bf16_f32 v63, v50, v51
    v_min_u32 v60, -2, v60
    v_min_u32 v61, -2, v61
    v_min_u32 v62, -2, v62
    v_min_u32 v63, -2, v63
    buffer_store_dwordx4 v[60:63], v2, s[28:31], s60 offen sc1
    s_cmp_eq_u32 s7, 0
    s_cbranch_scc1 LC_L
    s_setprio 3
    s_waitcnt lgkmcnt(0)
    s_waitcnt vmcnt(1)
    s_barrier
    buffer_load_dwordx4 v[12:15], v2, s[28:31], s66 offen offset:0 sc1
    buffer_load_dwordx4 v[16:19], v2, s[28:31], s66 offen offset:1024 sc1
    buffer_load_dwordx4 v[20:23], v2, s[28:31], s66 offen offset:2048 sc1
    buffer_load_dwordx4 v[24:27], v2, s[28:31], s66 offen offset:3072 sc1
    v_mfma_f32_32x32x16_bf16 v[144:159], v[224:227], v[116:119], v[144:159]
    s_mul_i32 m0, s3, 17408
    v_bfe_u32 v64, v1, 2, 2
    v_and_b32 v65, 1, v1
    v_lshl_or_b32 v64, v64, 1, v65
    v_mfma_f32_32x32x16_bf16 v[176:191], v[228:231], v[116:119], v[176:191]
    v_mul_u32_u24 v68, 528, v64
    v_bfe_u32 v64, v1, 4, 1
    v_mul_u32_u24 v64, 8704, v64
    v_and_b32 v65, 2, v1
    v_mfma_f32_32x32x16_bf16 v[128:143], v[224:227], v[112:115], v[128:143]
    v_lshl_add_u32 v68, v65, 6, v68
    v_lshrrev_b32 v65, 5, v1
    v_lshl_add_u32 v64, v65, 4, v64
    v_mfma_f32_32x32x16_bf16 v[160:175], v[228:231], v[112:115], v[160:175]
    s_mul_i32 s8, s7, 4352
    s_lshl_b32 s9, s6, 5
    s_add_u32 s8, s8, s9
    v_add3_u32 v68, v68, v64, s8
    buffer_load_dwordx4 v[28:31], v2, s[28:31], s64 offen offset:0 sc1
    buffer_load_dwordx4 v[32:35], v2, s[28:31], s64 offen offset:1024 sc1
    buffer_load_dwordx4 v[36:39], v2, s[28:31], s64 offen offset:2048 sc1
    buffer_load_dwordx4 v[40:43], v2, s[28:31], s64 offen offset:3072 sc1
    v_mfma_f32_32x32x16_bf16 v[144:159], v[232:235], v[100:103], v[144:159]
    v_add_u32 v69, 69632, v68
    v_and_b32 v64, 31, v1
    v_lshlrev_b32 v64, 2, v64
    v_lshl_add_u32 v7, v65, 12, v64
    v_mfma_f32_32x32x16_bf16 v[176:191], v[236:239], v[100:103], v[176:191]
    s_lshl_b32 s9, s57, 7
    s_add_u32 s67, s67, s9
    s_lshl_b32 s9, s3, 13
    s_add_u32 s67, s67, s9
    v_mfma_f32_32x32x16_bf16 v[128:143], v[232:235], v[96:99], v[128:143]
    v_mfma_f32_32x32x16_bf16 v[160:175], v[236:239], v[96:99], v[160:175]
    v_mfma_f32_32x32x16_bf16 v[144:159], v[240:243], v[252:255], v[144:159]
    v_mfma_f32_32x32x16_bf16 v[176:191], v[244:247], v[252:255], v[176:191]
    v_mfma_f32_32x32x16_bf16 v[128:143], v[240:243], v[248:251], v[128:143]
    v_mfma_f32_32x32x16_bf16 v[160:175], v[244:247], v[248:251], v[160:175]
    s_barrier
    ds_read_b128 v[224:227], v68 offset:0
    ds_read_b128 v[228:231], v68 offset:256
    ds_read_b128 v[232:235], v68 offset:17408
    ds_read_b128 v[236:239], v68 offset:17664
    ds_read_b128 v[240:243], v68 offset:34816
    ds_read_b128 v[244:247], v68 offset:35072
    ds_read_b128 v[248:251], v68 offset:52224
    ds_read_b128 v[252:255], v68 offset:52480
    s_branch Lo_7
Lo_7r:
    s_cmp_eq_u32 s61, 0
    s_cbranch_scc1 Lok_8
    s_sub_u32 s61, s61, 1
    s_sleep 1
    buffer_load_dwordx4 v[12:15], v2, s[28:31], s66 offen offset:0 sc1
    buffer_load_dwordx4 v[16:19], v2, s[28:31], s66 offen offset:1024 sc1
    buffer_load_dwordx4 v[20:23], v2, s[28:31], s66 offen offset:2048 sc1
    buffer_load_dwordx4 v[24:27], v2, s[28:31], s66 offen offset:3072 sc1
    buffer_load_dwordx4 v[28:31], v2, s[28:31], s64 offen offset:0 sc1
    buffer_load_dwordx4 v[32:35], v2, s[28:31], s64 offen offset:1024 sc1
    buffer_load_dwordx4 v[36:39], v2, s[28:31], s64 offen offset:2048 sc1
    buffer_load_dwordx4 v[40:43], v2, s[28:31], s64 offen offset:3072 sc1
Lo_7:
    s_waitcnt vmcnt(4)
    v_max3_u32 v8, v12, v13, v14
    v_max3_u32 v8, v8, v15, v16
    v_max3_u32 v8, v8, v17, v18
    v_max3_u32 v8, v8, v19, v20
    v_max3_u32 v8, v8, v21, v22
    v_max3_u32 v8, v8, v23, v24
    v_max3_u32 v8, v8, v25, v26
    v_max_u32 v8, v8, v27
    v_cmp_eq_u32 vcc, -1, v8
    s_cbranch_vccnz Lo_7r
Lok_8:
    v_mfma_f32_32x32x16_bf16 v[176:191], v[196:199], v[12:15], v[176:191]
    s_waitcnt lgkmcnt(0)
    v_add_f32 v224, v224, v232
    v_add_f32 v225, v225, v233
    v_add_f32 v226, v226, v234
    v_add_f32 v227, v227, v235
    v_add_f32 v228, v228, v236
    v_add_f32 v229, v229, v237
    v_mfma_f32_32x32x16_bf16 v[176:191], v[204:207], v[16:19], v[176:191]
    v_add_f32 v230, v230, v238
    v_add_f32 v231, v231, v239
    v_add_f32 v224, v224, v240
    v_add_f32 v225, v225, v241
    v_add_f32 v226, v226, v242
    v_add_f32 v227, v227, v243
    v_add_f32 v228, v228, v244
    v_mfma_f32_32x32x16_bf16 v[176:191], v[212:215], v[20:23], v[176:191]
    v_add_f32 v229, v229, v245
    v_add_f32 v230, v230, v246
    v_add_f32 v231, v231, v247
    v_add_f32 v224, v224, v248
    v_add_f32 v225, v225, v249
    v_add_f32 v226, v226, v250
    v_add_f32 v227, v227, v251
    v_mfma_f32_32x32x16_bf16 v[176:191], v[220:223], v[24:27], v[176:191]
    v_add_f32 v228, v228, v252
    v_add_f32 v229, v229, v253
    v_add_f32 v230, v230, v254
    v_add_f32 v231, v231, v255
    v_mfma_f32_32x32x16_bf16 v[144:159], v[192:195], v[12:15], v[144:159]
    s_nop 6
    ds_write_addtid_b32 v176 offset:13056
    v_mfma_f32_32x32x16_bf16 v[144:159], v[200:203], v[16:19], v[144:159]
    ds_write_addtid_b32 v177 offset:13312
    ds_write_addtid_b32 v178 offset:13584
    ds_write_addtid_b32 v179 offset:13840
    ds_write_addtid_b32 v180 offset:14112
    v_mfma_f32_32x32x16_bf16 v[144:159], v[208:211], v[20:23], v[144:159]
    ds_write_addtid_b32 v181 offset:14368
    ds_write_addtid_b32 v182 offset:14640
    ds_write_addtid_b32 v183 offset:14896
    ds_write_addtid_b32 v184 offset:15168
    v_mfma_f32_32x32x16_bf16 v[144:159], v[216:219], v[24:27], v[144:159]
    ds_write_addtid_b32 v185 offset:15424
    ds_write_addtid_b32 v186 offset:15696
    ds_write_addtid_b32 v187 offset:15952
    ds_write_addtid_b32 v188 offset:16224
    ds_write_addtid_b32 v189 offset:16480
    ds_write_addtid_b32 v190 offset:16752
    s_waitcnt vmcnt(0)
Lo_9:
    v_max3_u32 v8, v28, v29, v30
    v_max3_u32 v8, v8, v31, v32
    v_max3_u32 v8, v8, v33, v34
    v_max3_u32 v8, v8, v35, v36
    v_max3_u32 v8, v8, v37, v38
    v_max3_u32 v8, v8, v39, v40
    v_max3_u32 v8, v8, v41, v42
    v_max_u32 v8, v8, v43
    v_cmp_eq_u32 vcc, -1, v8
    s_cbranch_vccnz Lo_9r
Lok_10:
    v_mfma_f32_32x32x16_bf16 v[160:175], v[196:199], v[28:31], v[160:175]
    ds_write_addtid_b32 v191 offset:17008
    ds_write_addtid_b32 v144 offset:4352
    ds_write_addtid_b32 v145 offset:4608
    ds_write_addtid_b32 v146 offset:4880
    v_mfma_f32_32x32x16_bf16 v[160:175], v[204:207], v[32:35], v[160:175]
    ds_write_addtid_b32 v147 offset:5136
    ds_write_addtid_b32 v148 offset:5408
    ds_write_addtid_b32 v149 offset:5664
    ds_write_addtid_b32 v150 offset:5936
    v_mfma_f32_32x32x16_bf16 v[160:175], v[212:215], v[36:39], v[160:175]
    ds_write_addtid_b32 v151 offset:6192
    ds_write_addtid_b32 v152 offset:6464
    ds_write_addtid_b32 v153 offset:6720
    ds_write_addtid_b32 v154 offset:6992
    v_mfma_f32_32x32x16_bf16 v[160:175], v[220:223], v[40:43], v[160:175]
    ds_write_addtid_b32 v155 offset:7248
    ds_write_addtid_b32 v156 offset:7520
    ds_write_addtid_b32 v157 offset:7776
    ds_write_addtid_b32 v158 offset:8048
    v_mfma_f32_32x32x16_bf16 v[128:143], v[192:195], v[28:31], v[128:143]
    ds_write_addtid_b32 v159 offset:8304
    s_nop 5
    v_mfma_f32_32x32x16_bf16 v[128:143], v[200:203], v[32:35], v[128:143]
    ds_write_addtid_b32 v160 offset:8704
    ds_write_addtid_b32 v161 offset:8960
    ds_write_addtid_b32 v162 offset:9232
    ds_write_addtid_b32 v163 offset:9488
    v_mfma_f32_32x32x16_bf16 v[128:143], v[208:211], v[36:39], v[128:143]
    ds_write_addtid_b32 v164 offset:9760
    ds_write_addtid_b32 v165 offset:10016
    ds_write_addtid_b32 v166 offset:10288
    ds_write_addtid_b32 v167 offset:10544
    v_mfma_f32_32x32x16_bf16 v[128:143], v[216:219], v[40:43], v[128:143]
    ds_write_addtid_b32 v168 offset:10816
    ds_write_addtid_b32 v169 offset:11072
    ds_write_addtid_b32 v170 offset:11344
    ds_write_addtid_b32 v171 offset:11600
    ds_write_addtid_b32 v172 offset:11872
    ds_write_addtid_b32 v173 offset:12128
    ds_write_addtid_b32 v174 offset:12400
    ds_write_addtid_b32 v175 offset:12656
    s_nop 3
    ds_write_addtid_b32 v128 offset:0
    ds_write_addtid_b32 v129 offset:256
    ds_write_addtid_b32 v130 offset:528
    ds_write_addtid_b32 v131 offset:784
    ds_write_addtid_b32 v132 offset:1056
    ds_write_addtid_b32 v133 offset:1312
    ds_write_addtid_b32 v134 offset:1584
    ds_write_addtid_b32 v135 offset:1840
    ds_write_addtid_b32 v136 offset:2112
    ds_write_addtid_b32 v137 offset:2368
    ds_write_addtid_b32 v138 offset:2640
    ds_write_addtid_b32 v139 offset:2896
    ds_write_addtid_b32 v140 offset:3168
    ds_write_addtid_b32 v141 offset:3424
    ds_write_addtid_b32 v142 offset:3696
    ds_write_addtid_b32 v143 offset:3952
    s_waitcnt lgkmcnt(0)
LC_red:
    s_barrier
    ds_read_b128 v[160:163], v69 offset:0
    ds_read_b128 v[164:167], v69 offset:256
    ds_read_b128 v[168:171], v69 offset:17408
    ds_read_b128 v[172:175], v69 offset:17664
    ds_read_b128 v[176:179], v69 offset:34816
    ds_read_b128 v[180:183], v69 offset:35072
    ds_read_b128 v[184:187], v69 offset:52224
    ds_read_b128 v[188:191], v69 offset:52480
    s_waitcnt lgkmcnt(6)
    v_pk_add_f32 v[224:225], v[224:225], v[160:161]
    v_pk_add_f32 v[226:227], v[226:227], v[162:163]
    v_pk_add_f32 v[228:229], v[228:229], v[164:165]
    v_pk_add_f32 v[230:231], v[230:231], v[166:167]
    s_waitcnt lgkmcnt(4)
    v_pk_add_f32 v[224:225], v[224:225], v[168:169]
    v_pk_add_f32 v[226:227], v[226:227], v[170:171]
    v_pk_add_f32 v[228:229], v[228:229], v[172:173]
    v_pk_add_f32 v[230:231], v[230:231], v[174:175]
    s_waitcnt lgkmcnt(2)
    v_pk_add_f32 v[224:225], v[224:225], v[176:177]
    v_pk_add_f32 v[226:227], v[226:227], v[178:179]
    v_pk_add_f32 v[228:229], v[228:229], v[180:181]
    v_pk_add_f32 v[230:231], v[230:231], v[182:183]
    s_waitcnt lgkmcnt(0)
    v_pk_add_f32 v[224:225], v[224:225], v[184:185]
    v_pk_add_f32 v[226:227], v[226:227], v[186:187]
    v_pk_add_f32 v[228:229], v[228:229], v[188:189]
    v_pk_add_f32 v[230:231], v[230:231], v[190:191]
    v_cvt_pk_bf16_f32 v12, v224, v228
    buffer_store_dword v12, v7, s[40:43], s67 offen offset:0 sc1
    v_cvt_pk_bf16_f32 v13, v225, v229
    buffer_store_dword v13, v7, s[40:43], s67 offen offset:1024 sc1
    v_cvt_pk_bf16_f32 v14, v226, v230
    buffer_store_dword v14, v7, s[40:43], s67 offen offset:2048 sc1
    v_cvt_pk_bf16_f32 v15, v227, v231
    buffer_store_dword v15, v7, s[40:43], s67 offen offset:3072 sc1
    s_endpgm
Lo_9r:
    s_cmp_eq_u32 s61, 0
    s_cbranch_scc1 Lok_10
    s_sub_u32 s61, s61, 1
    s_sleep 1
    buffer_load_dwordx4 v[28:31], v2, s[28:31], s64 offen offset:0 sc1
    buffer_load_dwordx4 v[32:35], v2, s[28:31], s64 offen offset:1024 sc1
    buffer_load_dwordx4 v[36:39], v2, s[28:31], s64 offen offset:2048 sc1
    buffer_load_dwordx4 v[40:43], v2, s[28:31], s64 offen offset:3072 sc1
    s_waitcnt vmcnt(0)
    s_branch Lo_9
Lpoll_4:
    s_cmp_eq_u32 s61, 0
    s_cbranch_scc1 Lpok_5
    s_sub_u32 s61, s61, 1
    s_sleep 16
    buffer_load_dword v121, v120, s[28:31], s72 offen sc1
    s_waitcnt vmcnt(0)
    v_cmp_ne_u32 vcc, v8, v121
    s_cbranch_vccnz Lpoll_4
    s_branch Lpok_5
LC_L:
    s_setprio 0
    s_waitcnt lgkmcnt(0)
    s_waitcnt vmcnt(1)
    v_mfma_f32_32x32x16_bf16 v[144:159], v[224:227], v[116:119], v[144:159]
    s_mul_i32 m0, s3, 17408
    v_bfe_u32 v64, v1, 2, 2
    v_and_b32 v65, 1, v1
    v_lshl_or_b32 v64, v64, 1, v65
    v_mfma_f32_32x32x16_bf16 v[176:191], v[228:231], v[116:119], v[176:191]
    v_mul_u32_u24 v68, 528, v64
    v_bfe_u32 v64, v1, 4, 1
    v_mul_u32_u24 v64, 8704, v64
    v_and_b32 v65, 2, v1
    v_mfma_f32_32x32x16_bf16 v[128:143], v[224:227], v[112:115], v[128:143]
    v_lshl_add_u32 v68, v65, 6, v68
    v_lshrrev_b32 v65, 5, v1
    v_lshl_add_u32 v64, v65, 4, v64
    v_mfma_f32_32x32x16_bf16 v[160:175], v[228:231], v[112:115], v[160:175]
    s_mul_i32 s8, s7, 4352
    s_lshl_b32 s9, s6, 5
    s_add_u32 s8, s8, s9
    v_add3_u32 v68, v68, v64, s8
    v_mfma_f32_32x32x16_bf16 v[144:159], v[232:235], v[100:103], v[144:159]
    v_add_u32 v69, 69632, v68
    v_and_b32 v64, 31, v1
    v_lshlrev_b32 v64, 2, v64
    v_lshl_add_u32 v7, v65, 12, v64
    v_mfma_f32_32x32x16_bf16 v[176:191], v[236:239], v[100:103], v[176:191]
    s_lshl_b32 s9, s57, 7
    s_add_u32 s67, s67, s9
    s_lshl_b32 s9, s3, 13
    s_add_u32 s67, s67, s9
    buffer_load_dwordx4 v[12:15], v2, s[28:31], s66 offen offset:0 sc1
    buffer_load_dwordx4 v[16:19], v2, s[28:31], s66 offen offset:1024 sc1
    buffer_load_dwordx4 v[20:23], v2, s[28:31], s66 offen offset:2048 sc1
    buffer_load_dwordx4 v[24:27], v2, s[28:31], s66 offen offset:3072 sc1
    buffer_load_dwordx4 v[28:31], v2, s[28:31], s64 offen offset:0 sc1
    buffer_load_dwordx4 v[32:35], v2, s[28:31], s64 offen offset:1024 sc1
    buffer_load_dwordx4 v[36:39], v2, s[28:31], s64 offen offset:2048 sc1
    buffer_load_dwordx4 v[40:43], v2, s[28:31], s64 offen offset:3072 sc1
    v_mfma_f32_32x32x16_bf16 v[128:143], v[232:235], v[96:99], v[128:143]
    v_mfma_f32_32x32x16_bf16 v[160:175], v[236:239], v[96:99], v[160:175]
    v_mfma_f32_32x32x16_bf16 v[144:159], v[240:243], v[252:255], v[144:159]
    v_mfma_f32_32x32x16_bf16 v[176:191], v[244:247], v[252:255], v[176:191]
    v_mfma_f32_32x32x16_bf16 v[128:143], v[240:243], v[248:251], v[128:143]
    v_mfma_f32_32x32x16_bf16 v[160:175], v[244:247], v[248:251], v[160:175]
    s_branch Lo_11
Lo_11r:
    s_cmp_eq_u32 s61, 0
    s_cbranch_scc1 Lok_12
    s_sub_u32 s61, s61, 1
    s_sleep 2
    buffer_load_dwordx4 v[12:15], v2, s[28:31], s66 offen offset:0 sc1
    buffer_load_dwordx4 v[16:19], v2, s[28:31], s66 offen offset:1024 sc1
    buffer_load_dwordx4 v[20:23], v2, s[28:31], s66 offen offset:2048 sc1
    buffer_load_dwordx4 v[24:27], v2, s[28:31], s66 offen offset:3072 sc1
    buffer_load_dwordx4 v[28:31], v2, s[28:31], s64 offen offset:0 sc1
    buffer_load_dwordx4 v[32:35], v2, s[28:31], s64 offen offset:1024 sc1
    buffer_load_dwordx4 v[36:39], v2, s[28:31], s64 offen offset:2048 sc1
    buffer_load_dwordx4 v[40:43], v2, s[28:31], s64 offen offset:3072 sc1
Lo_11:
    s_waitcnt vmcnt(4)
    v_max3_u32 v8, v12, v13, v14
    v_max3_u32 v8, v8, v15, v16
    v_max3_u32 v8, v8, v17, v18
    v_max3_u32 v8, v8, v19, v20
    v_max3_u32 v8, v8, v21, v22
    v_max3_u32 v8, v8, v23, v24
    v_max3_u32 v8, v8, v25, v26
    v_max_u32 v8, v8, v27
    v_cmp_eq_u32 vcc, -1, v8
    s_cbranch_vccnz Lo_11r
Lok_12:
    v_mfma_f32_32x32x16_bf16 v[176:191], v[196:199], v[12:15], v[176:191]
    v_mfma_f32_32x32x16_bf16 v[176:191], v[204:207], v[16:19], v[176:191]
    v_mfma_f32_32x32x16_bf16 v[176:191], v[212:215], v[20:23], v[176:191]
    v_mfma_f32_32x32x16_bf16 v[176:191], v[220:223], v[24:27], v[176:191]
    v_mfma_f32_32x32x16_bf16 v[144:159], v[192:195], v[12:15], v[144:159]
    v_mfma_f32_32x32x16_bf16 v[144:159], v[200:203], v[16:19], v[144:159]
    v_mfma_f32_32x32x16_bf16 v[144:159], v[208:211], v[20:23], v[144:159]
    v_mfma_f32_32x32x16_bf16 v[144:159], v[216:219], v[24:27], v[144:159]
    s_waitcnt vmcnt(0)
Lo_13:
    v_max3_u32 v8, v28, v29, v30
    v_max3_u32 v8, v8, v31, v32
    v_max3_u32 v8, v8, v33, v34
    v_max3_u32 v8, v8, v35, v36
    v_max3_u32 v8, v8, v37, v38
    v_max3_u32 v8, v8, v39, v40
    v_max3_u32 v8, v8, v41, v42
    v_max_u32 v8, v8, v43
    v_cmp_eq_u32 vcc, -1, v8
    s_cbranch_vccnz Lo_13r
Lok_14:
    v_mfma_f32_32x32x16_bf16 v[160:175], v[196:199], v[28:31], v[160:175]
    v_mfma_f32_32x32x16_bf16 v[160:175], v[204:207], v[32:35], v[160:175]
    v_mfma_f32_32x32x16_bf16 v[160:175], v[212:215], v[36:39], v[160:175]
    v_mfma_f32_32x32x16_bf16 v[160:175], v[220:223], v[40:43], v[160:175]
    v_mfma_f32_32x32x16_bf16 v[128:143], v[192:195], v[28:31], v[128:143]
    v_mfma_f32_32x32x16_bf16 v[128:143], v[200:203], v[32:35], v[128:143]
    v_mfma_f32_32x32x16_bf16 v[128:143], v[208:211], v[36:39], v[128:143]
    v_mfma_f32_32x32x16_bf16 v[128:143], v[216:219], v[40:43], v[128:143]
    s_barrier
    ds_write_addtid_b32 v176 offset:13056
    ds_write_addtid_b32 v177 offset:13312
    ds_write_addtid_b32 v178 offset:13584
    ds_write_addtid_b32 v179 offset:13840
    ds_write_addtid_b32 v180 offset:14112
    ds_write_addtid_b32 v181 offset:14368
    ds_write_addtid_b32 v182 offset:14640
    ds_write_addtid_b32 v183 offset:14896
    ds_write_addtid_b32 v184 offset:15168
    ds_write_addtid_b32 v185 offset:15424
    ds_write_addtid_b32 v186 offset:15696
    ds_write_addtid_b32 v187 offset:15952
    ds_write_addtid_b32 v188 offset:16224
    ds_write_addtid_b32 v189 offset:16480
    ds_write_addtid_b32 v190 offset:16752
    ds_write_addtid_b32 v191 offset:17008
    ds_write_addtid_b32 v144 offset:4352
    ds_write_addtid_b32 v145 offset:4608
    ds_write_addtid_b32 v146 offset:4880
    ds_write_addtid_b32 v147 offset:5136
    ds_write_addtid_b32 v148 offset:5408
    ds_write_addtid_b32 v149 offset:5664
    ds_write_addtid_b32 v150 offset:5936
    ds_write_addtid_b32 v151 offset:6192
    ds_write_addtid_b32 v152 offset:6464
    ds_write_addtid_b32 v153 offset:6720
    ds_write_addtid_b32 v154 offset:6992
    ds_write_addtid_b32 v155 offset:7248
    ds_write_addtid_b32 v156 offset:7520
    ds_write_addtid_b32 v157 offset:7776
    ds_write_addtid_b32 v158 offset:8048
    ds_write_addtid_b32 v159 offset:8304
    ds_write_addtid_b32 v160 offset:8704
    ds_write_addtid_b32 v161 offset:8960
    ds_write_addtid_b32 v162 offset:9232
    ds_write_addtid_b32 v163 offset:9488
    ds_write_addtid_b32 v164 offset:9760
    ds_write_addtid_b32 v165 offset:10016
    ds_write_addtid_b32 v166 offset:10288
    ds_write_addtid_b32 v167 offset:10544
    ds_write_addtid_b32 v168 offset:10816
    ds_write_addtid_b32 v169 offset:11072
    ds_write_addtid_b32 v170 offset:11344
    ds_write_addtid_b32 v171 offset:11600
    ds_write_addtid_b32 v172 offset:11872
    ds_write_addtid_b32 v173 offset:12128
    ds_write_addtid_b32 v174 offset:12400
    ds_write_addtid_b32 v175 offset:12656
    ds_write_addtid_b32 v128 offset:0
    ds_write_addtid_b32 v129 offset:256
    ds_write_addtid_b32 v130 offset:528
    ds_write_addtid_b32 v131 offset:784
    ds_write_addtid_b32 v132 offset:1056
    ds_write_addtid_b32 v133 offset:1312
    ds_write_addtid_b32 v134 offset:1584
    ds_write_addtid_b32 v135 offset:1840
    ds_write_addtid_b32 v136 offset:2112
    ds_write_addtid_b32 v137 offset:2368
    ds_write_addtid_b32 v138 offset:2640
    ds_write_addtid_b32 v139 offset:2896
    ds_write_addtid_b32 v140 offset:3168
    ds_write_addtid_b32 v141 offset:3424
    ds_write_addtid_b32 v142 offset:3696
    ds_write_addtid_b32 v143 offset:3952
    s_waitcnt lgkmcnt(0)
    s_barrier
    ds_read_b128 v[224:227], v68 offset:0
    ds_read_b128 v[228:231], v68 offset:256
    ds_read_b128 v[232:235], v68 offset:17408
    ds_read_b128 v[236:239], v68 offset:17664
    ds_read_b128 v[240:243], v68 offset:34816
    ds_read_b128 v[244:247], v68 offset:35072
    ds_read_b128 v[248:251], v68 offset:52224
    ds_read_b128 v[252:255], v68 offset:52480
    s_waitcnt lgkmcnt(0)
    v_add_f32 v224, v224, v232
    v_add_f32 v225, v225, v233
    v_add_f32 v226, v226, v234
    v_add_f32 v227, v227, v235
    v_add_f32 v228, v228, v236
    v_add_f32 v229, v229, v237
    v_add_f32 v230, v230, v238
    v_add_f32 v231, v231, v239
    v_add_f32 v224, v224, v240
    v_add_f32 v225, v225, v241
    v_add_f32 v226, v226, v242
    v_add_f32 v227, v227, v243
    v_add_f32 v228, v228, v244
    v_add_f32 v229, v229, v245
    v_add_f32 v230, v230, v246
    v_add_f32 v231, v231, v247
    v_add_f32 v224, v224, v248
    v_add_f32 v225, v225, v249
    v_add_f32 v226, v226, v250
    v_add_f32 v227, v227, v251
    v_add_f32 v228, v228, v252
    v_add_f32 v229, v229, v253
    v_add_f32 v230, v230, v254
    v_add_f32 v231, v231, v255
    s_setprio 1
    s_branch LC_red
Lo_13r:
    s_cmp_eq_u32 s61, 0
    s_cbranch_scc1 Lok_14
    s_sub_u32 s61, s61, 1
    s_sleep 2
    buffer_load_dwordx4 v[28:31], v2, s[28:31], s64 offen offset:0 sc1
    buffer_load_dwordx4 v[32:35], v2, s[28:31], s64 offen offset:1024 sc1
    buffer_load_dwordx4 v[36:39], v2, s[28:31], s64 offen offset:2048 sc1
    buffer_load_dwordx4 v[40:43], v2, s[28:31], s64 offen offset:3072 sc1
    s_waitcnt vmcnt(0)
    s_branch Lo_13
LA_N2:
    s_setprio 2
    v_xor_b32 v88, s49, v88
    v_xor_b32 v89, s49, v89
    s_and_b32 s9, s3, 1
    s_lshl_b32 s9, s9, 9
    v_lshl_add_u32 v126, v120, 2, s9
    s_barrier
    ds_read_b128 v[224:227], v88 offset:0
    ds_read_b64_tr_b16 v[12:13], v90 offset:0
    ds_read_b64_tr_b16 v[14:15], v90 offset:768
    ds_read_b128 v[228:231], v88 offset:2048
    ds_read_b128 v[232:235], v88 offset:4096
    ds_read_b128 v[236:239], v88 offset:6144
    ds_read_b64_tr_b16 v[16:17], v90 offset:3072
    ds_read_b64_tr_b16 v[18:19], v90 offset:3840
    ds_read_b64_tr_b16 v[20:21], v91 offset:0
    ds_read_b64_tr_b16 v[22:23], v91 offset:768
    s_waitcnt lgkmcnt(7)
    v_mfma_f32_16x16x32_bf16 v[128:131], v[12:15], v[224:227], 0
    ds_read_b64_tr_b16 v[24:25], v91 offset:3072
    s_waitcnt lgkmcnt(7)
    v_mfma_f32_16x16x32_bf16 v[132:135], v[12:15], v[228:231], 0
    ds_read_b64_tr_b16 v[26:27], v91 offset:3840
    s_waitcnt lgkmcnt(7)
    v_mfma_f32_16x16x32_bf16 v[136:139], v[12:15], v[232:235], 0
    ds_read_b128 v[240:243], v89 offset:0
    s_waitcnt lgkmcnt(7)
    v_mfma_f32_16x16x32_bf16 v[140:143], v[12:15], v[236:239], 0
    ds_read_b128 v[244:247], v89 offset:2048
    s_waitcnt lgkmcnt(6)
    v_mfma_f32_16x16x32_bf16 v[156:159], v[16:19], v[236:239], 0
    s_barrier
    ds_read_b64_tr_b16 v[12:13], v90 offset:12288
    v_mfma_f32_16x16x32_bf16 v[152:155], v[16:19], v[232:235], 0
    ds_read_b64_tr_b16 v[14:15], v90 offset:13056
    v_mfma_f32_16x16x32_bf16 v[148:151], v[16:19], v[228:231], 0
    ds_read_b128 v[248:251], v89 offset:4096
    v_mfma_f32_16x16x32_bf16 v[144:147], v[16:19], v[224:227], 0
    ds_read_b128 v[252:255], v89 offset:6144
    s_waitcnt lgkmcnt(8)
    v_mfma_f32_16x16x32_bf16 v[160:163], v[20:23], v[224:227], 0
    ds_read_b64_tr_b16 v[16:17], v90 offset:15360
    v_mfma_f32_16x16x32_bf16 v[164:167], v[20:23], v[228:231], 0
    ds_read_b64_tr_b16 v[18:19], v90 offset:16128
    v_mfma_f32_16x16x32_bf16 v[168:171], v[20:23], v[232:235], 0
    v_mfma_f32_16x16x32_bf16 v[172:175], v[20:23], v[236:239], 0
    s_waitcnt lgkmcnt(8)
    v_mfma_f32_16x16x32_bf16 v[188:191], v[24:27], v[236:239], 0
    ds_read_b64_tr_b16 v[20:21], v91 offset:12288
    v_mfma_f32_16x16x32_bf16 v[184:187], v[24:27], v[232:235], 0
    ds_read_b64_tr_b16 v[22:23], v91 offset:13056
    v_mfma_f32_16x16x32_bf16 v[180:183], v[24:27], v[228:231], 0
    v_mfma_f32_16x16x32_bf16 v[176:179], v[24:27], v[224:227], 0
    s_waitcnt lgkmcnt(4)
    v_mfma_f32_16x16x32_bf16 v[128:131], v[12:15], v[240:243], v[128:131]
    ds_read_b64_tr_b16 v[24:25], v91 offset:15360
    v_mfma_f32_16x16x32_bf16 v[132:135], v[12:15], v[244:247], v[132:135]
    ds_read_b64_tr_b16 v[26:27], v91 offset:16128
    v_mfma_f32_16x16x32_bf16 v[136:139], v[12:15], v[248:251], v[136:139]
    v_mfma_f32_16x16x32_bf16 v[140:143], v[12:15], v[252:255], v[140:143]
    s_waitcnt lgkmcnt(4)
    v_mfma_f32_16x16x32_bf16 v[156:159], v[16:19], v[252:255], v[156:159]
    s_barrier
    ds_read_b128 v[224:227], v88 offset:16384
    v_mfma_f32_16x16x32_bf16 v[152:155], v[16:19], v[248:251], v[152:155]
    ds_read_b64_tr_b16 v[12:13], v90 offset:24576
    v_mfma_f32_16x16x32_bf16 v[148:151], v[16:19], v[244:247], v[148:151]
    ds_read_b64_tr_b16 v[14:15], v90 offset:25344
    v_mfma_f32_16x16x32_bf16 v[144:147], v[16:19], v[240:243], v[144:147]
    ds_read_b128 v[228:231], v88 offset:18432
    s_waitcnt lgkmcnt(6)
    v_mfma_f32_16x16x32_bf16 v[160:163], v[20:23], v[240:243], v[160:163]
    ds_read_b128 v[232:235], v88 offset:20480
    v_mfma_f32_16x16x32_bf16 v[164:167], v[20:23], v[244:247], v[164:167]
    ds_read_b128 v[236:239], v88 offset:22528
    v_mfma_f32_16x16x32_bf16 v[168:171], v[20:23], v[248:251], v[168:171]
    ds_read_b64_tr_b16 v[16:17], v90 offset:27648
    v_mfma_f32_16x16x32_bf16 v[172:175], v[20:23], v[252:255], v[172:175]
    ds_read_b64_tr_b16 v[18:19], v90 offset:28416
    s_waitcnt lgkmcnt(8)
    v_mfma_f32_16x16x32_bf16 v[188:191], v[24:27], v[252:255], v[188:191]
    ds_read_b64_tr_b16 v[20:21], v91 offset:24576
    v_mfma_f32_16x16x32_bf16 v[184:187], v[24:27], v[248:251], v[184:187]
    ds_read_b64_tr_b16 v[22:23], v91 offset:25344
    v_mfma_f32_16x16x32_bf16 v[180:183], v[24:27], v[244:247], v[180:183]
    v_mfma_f32_16x16x32_bf16 v[176:179], v[24:27], v[240:243], v[176:179]
    s_waitcnt lgkmcnt(4)
    v_mfma_f32_16x16x32_bf16 v[128:131], v[12:15], v[224:227], v[128:131]
    ds_read_b64_tr_b16 v[24:25], v91 offset:27648
    v_mfma_f32_16x16x32_bf16 v[132:135], v[12:15], v[228:231], v[132:135]
    ds_read_b64_tr_b16 v[26:27], v91 offset:28416
    v_mfma_f32_16x16x32_bf16 v[136:139], v[12:15], v[232:235], v[136:139]
    ds_read_b128 v[240:243], v89 offset:16384
    v_mfma_f32_16x16x32_bf16 v[140:143], v[12:15], v[236:239], v[140:143]
    ds_read_b128 v[244:247], v89 offset:18432
    s_waitcnt lgkmcnt(6)
    v_mfma_f32_16x16x32_bf16 v[156:159], v[16:19], v[236:239], v[156:159]
    s_barrier
    ds_read_b64_tr_b16 v[12:13], v90 offset:36864
    v_mfma_f32_16x16x32_bf16 v[152:155], v[16:19], v[232:235], v[152:155]
    ds_read_b64_tr_b16 v[14:15], v90 offset:37632
    v_mfma_f32_16x16x32_bf16 v[148:151], v[16:19], v[228:231], v[148:151]
    ds_read_b128 v[248:251], v89 offset:20480
    v_mfma_f32_16x16x32_bf16 v[144:147], v[16:19], v[224:227], v[144:147]
    ds_read_b128 v[252:255], v89 offset:22528
    s_waitcnt lgkmcnt(8)
    v_mfma_f32_16x16x32_bf16 v[160:163], v[20:23], v[224:227], v[160:163]
    ds_read_b64_tr_b16 v[16:17], v90 offset:39936
    v_mfma_f32_16x16x32_bf16 v[164:167], v[20:23], v[228:231], v[164:167]
    ds_read_b64_tr_b16 v[18:19], v90 offset:40704
    v_mfma_f32_16x16x32_bf16 v[168:171], v[20:23], v[232:235], v[168:171]
    v_mfma_f32_16x16x32_bf16 v[172:175], v[20:23], v[236:239], v[172:175]
    s_waitcnt lgkmcnt(8)
    v_mfma_f32_16x16x32_bf16 v[188:191], v[24:27], v[236:239], v[188:191]
    ds_read_b64_tr_b16 v[20:21], v91 offset:36864
    v_mfma_f32_16x16x32_bf16 v[184:187], v[24:27], v[232:235], v[184:187]
    ds_read_b64_tr_b16 v[22:23], v91 offset:37632
    v_mfma_f32_16x16x32_bf16 v[180:183], v[24:27], v[228:231], v[180:183]
    v_mfma_f32_16x16x32_bf16 v[176:179], v[24:27], v[224:227], v[176:179]
    s_waitcnt lgkmcnt(4)
    v_mfma_f32_16x16x32_bf16 v[128:131], v[12:15], v[240:243], v[128:131]
    ds_read_b64_tr_b16 v[24:25], v91 offset:39936
    v_mfma_f32_16x16x32_bf16 v[132:135], v[12:15], v[244:247], v[132:135]
    ds_read_b64_tr_b16 v[26:27], v91 offset:40704
    v_mfma_f32_16x16x32_bf16 v[136:139], v[12:15], v[248:251], v[136:139]
    v_mfma_f32_16x16x32_bf16 v[140:143], v[12:15], v[252:255], v[140:143]
    s_waitcnt lgkmcnt(4)
    v_mfma_f32_16x16x32_bf16 v[156:159], v[16:19], v[252:255], v[156:159]
    s_barrier
    ds_read_b128 v[224:227], v88 offset:32768
    v_mfma_f32_16x16x32_bf16 v[152:155], v[16:19], v[248:251], v[152:155]
    ds_read_b64_tr_b16 v[12:13], v90 offset:0
    v_mfma_f32_16x16x32_bf16 v[148:151], v[16:19], v[244:247], v[148:151]
    ds_read_b64_tr_b16 v[14:15], v90 offset:768
    v_mfma_f32_16x16x32_bf16 v[144:147], v[16:19], v[240:243], v[144:147]
    ds_read_b128 v[228:231], v88 offset:34816
    s_waitcnt lgkmcnt(6)
    v_mfma_f32_16x16x32_bf16 v[160:163], v[20:23], v[240:243], v[160:163]
    ds_read_b128 v[232:235], v88 offset:36864
    v_mfma_f32_16x16x32_bf16 v[164:167], v[20:23], v[244:247], v[164:167]
    ds_read_b128 v[236:239], v88 offset:38912
    v_mfma_f32_16x16x32_bf16 v[168:171], v[20:23], v[248:251], v[168:171]
    ds_read_b64_tr_b16 v[16:17], v90 offset:3072
    v_mfma_f32_16x16x32_bf16 v[172:175], v[20:23], v[252:255], v[172:175]
    ds_read_b64_tr_b16 v[18:19], v90 offset:3840
    s_waitcnt lgkmcnt(8)
    v_mfma_f32_16x16x32_bf16 v[188:191], v[24:27], v[252:255], v[188:191]
    ds_read_b64_tr_b16 v[20:21], v91 offset:0
    v_mfma_f32_16x16x32_bf16 v[184:187], v[24:27], v[248:251], v[184:187]
    ds_read_b64_tr_b16 v[22:23], v91 offset:768
    v_mfma_f32_16x16x32_bf16 v[180:183], v[24:27], v[244:247], v[180:183]
    v_mfma_f32_16x16x32_bf16 v[176:179], v[24:27], v[240:243], v[176:179]
    s_waitcnt lgkmcnt(4)
    v_mfma_f32_16x16x32_bf16 v[128:131], v[12:15], v[224:227], v[128:131]
    ds_read_b64_tr_b16 v[24:25], v91 offset:3072
    v_mfma_f32_16x16x32_bf16 v[132:135], v[12:15], v[228:231], v[132:135]
    ds_read_b64_tr_b16 v[26:27], v91 offset:3840
    v_mfma_f32_16x16x32_bf16 v[136:139], v[12:15], v[232:235], v[136:139]
    ds_read_b128 v[240:243], v89 offset:32768
    v_mfma_f32_16x16x32_bf16 v[140:143], v[12:15], v[236:239], v[140:143]
    ds_read_b128 v[244:247], v89 offset:34816
    s_waitcnt lgkmcnt(6)
    v_mfma_f32_16x16x32_bf16 v[156:159], v[16:19], v[236:239], v[156:159]
    s_barrier
    ds_read_b64_tr_b16 v[12:13], v90 offset:12288
    v_mfma_f32_16x16x32_bf16 v[152:155], v[16:19], v[232:235], v[152:155]
    ds_read_b64_tr_b16 v[14:15], v90 offset:13056
    v_mfma_f32_16x16x32_bf16 v[148:151], v[16:19], v[228:231], v[148:151]
    ds_read_b128 v[248:251], v89 offset:36864
    v_mfma_f32_16x16x32_bf16 v[144:147], v[16:19], v[224:227], v[144:147]
    ds_read_b128 v[252:255], v89 offset:38912
    s_waitcnt lgkmcnt(8)
    v_mfma_f32_16x16x32_bf16 v[160:163], v[20:23], v[224:227], v[160:163]
    ds_read_b64_tr_b16 v[16:17], v90 offset:15360
    v_mfma_f32_16x16x32_bf16 v[164:167], v[20:23], v[228:231], v[164:167]
    ds_read_b64_tr_b16 v[18:19], v90 offset:16128
    v_mfma_f32_16x16x32_bf16 v[168:171], v[20:23], v[232:235], v[168:171]
    v_mfma_f32_16x16x32_bf16 v[172:175], v[20:23], v[236:239], v[172:175]
    s_waitcnt lgkmcnt(8)
    v_mfma_f32_16x16x32_bf16 v[188:191], v[24:27], v[236:239], v[188:191]
    ds_read_b64_tr_b16 v[20:21], v91 offset:12288
    v_mfma_f32_16x16x32_bf16 v[184:187], v[24:27], v[232:235], v[184:187]
    ds_read_b64_tr_b16 v[22:23], v91 offset:13056
    v_mfma_f32_16x16x32_bf16 v[180:183], v[24:27], v[228:231], v[180:183]
    v_mfma_f32_16x16x32_bf16 v[176:179], v[24:27], v[224:227], v[176:179]
    s_waitcnt lgkmcnt(4)
    v_mfma_f32_16x16x32_bf16 v[128:131], v[12:15], v[240:243], v[128:131]
    ds_read_b64_tr_b16 v[24:25], v91 offset:15360
    v_mfma_f32_16x16x32_bf16 v[132:135], v[12:15], v[244:247], v[132:135]
    ds_read_b64_tr_b16 v[26:27], v91 offset:16128
    v_mfma_f32_16x16x32_bf16 v[136:139], v[12:15], v[248:251], v[136:139]
    v_mfma_f32_16x16x32_bf16 v[140:143], v[12:15], v[252:255], v[140:143]
    s_waitcnt lgkmcnt(4)
    v_mfma_f32_16x16x32_bf16 v[156:159], v[16:19], v[252:255], v[156:159]
    s_barrier
    ds_read_b128 v[224:227], v88 offset:0
    v_mfma_f32_16x16x32_bf16 v[152:155], v[16:19], v[248:251], v[152:155]
    ds_read_b64_tr_b16 v[12:13], v90 offset:24576
    v_mfma_f32_16x16x32_bf16 v[148:151], v[16:19], v[244:247], v[148:151]
    ds_read_b64_tr_b16 v[14:15], v90 offset:25344
    v_mfma_f32_16x16x32_bf16 v[144:147], v[16:19], v[240:243], v[144:147]
    ds_read_b128 v[228:231], v88 offset:2048
    s_waitcnt lgkmcnt(6)
    v_mfma_f32_16x16x32_bf16 v[160:163], v[20:23], v[240:243], v[160:163]
    ds_read_b128 v[232:235], v88 offset:4096
    v_mfma_f32_16x16x32_bf16 v[164:167], v[20:23], v[244:247], v[164:167]
    ds_read_b128 v[236:239], v88 offset:6144
    v_mfma_f32_16x16x32_bf16 v[168:171], v[20:23], v[248:251], v[168:171]
    ds_read_b64_tr_b16 v[16:17], v90 offset:27648
    v_mfma_f32_16x16x32_bf16 v[172:175], v[20:23], v[252:255], v[172:175]
    ds_read_b64_tr_b16 v[18:19], v90 offset:28416
    s_waitcnt lgkmcnt(8)
    v_mfma_f32_16x16x32_bf16 v[188:191], v[24:27], v[252:255], v[188:191]
    ds_read_b64_tr_b16 v[20:21], v91 offset:24576
    v_mfma_f32_16x16x32_bf16 v[184:187], v[24:27], v[248:251], v[184:187]
    ds_read_b64_tr_b16 v[22:23], v91 offset:25344
    v_mfma_f32_16x16x32_bf16 v[180:183], v[24:27], v[244:247], v[180:183]
    v_mfma_f32_16x16x32_bf16 v[176:179], v[24:27], v[240:243], v[176:179]
    s_waitcnt lgkmcnt(4)
    v_mfma_f32_16x16x32_bf16 v[128:131], v[12:15], v[224:227], v[128:131]
    ds_read_b64_tr_b16 v[24:25], v91 offset:27648
    v_mfma_f32_16x16x32_bf16 v[132:135], v[12:15], v[228:231], v[132:135]
    ds_read_b64_tr_b16 v[26:27], v91 offset:28416
    v_mfma_f32_16x16x32_bf16 v[136:139], v[12:15], v[232:235], v[136:139]
    ds_read_b128 v[240:243], v89 offset:0
    v_mfma_f32_16x16x32_bf16 v[140:143], v[12:15], v[236:239], v[140:143]
    ds_read_b128 v[244:247], v89 offset:2048
    s_waitcnt lgkmcnt(6)
    v_mfma_f32_16x16x32_bf16 v[156:159], v[16:19], v[236:239], v[156:159]
    s_barrier
    ds_read_b64_tr_b16 v[12:13], v90 offset:36864
    v_mfma_f32_16x16x32_bf16 v[152:155], v[16:19], v[232:235], v[152:155]
    ds_read_b64_tr_b16 v[14:15], v90 offset:37632
    v_mfma_f32_16x16x32_bf16 v[148:151], v[16:19], v[228:231], v[148:151]
    ds_read_b128 v[248:251], v89 offset:4096
    v_mfma_f32_16x16x32_bf16 v[144:147], v[16:19], v[224:227], v[144:147]
    ds_read_b128 v[252:255], v89 offset:6144
    s_waitcnt lgkmcnt(8)
    v_mfma_f32_16x16x32_bf16 v[160:163], v[20:23], v[224:227], v[160:163]
    ds_read_b64_tr_b16 v[16:17], v90 offset:39936
    v_mfma_f32_16x16x32_bf16 v[164:167], v[20:23], v[228:231], v[164:167]
    ds_read_b64_tr_b16 v[18:19], v90 offset:40704
    v_mfma_f32_16x16x32_bf16 v[168:171], v[20:23], v[232:235], v[168:171]
    v_mfma_f32_16x16x32_bf16 v[172:175], v[20:23], v[236:239], v[172:175]
    s_waitcnt lgkmcnt(8)
    v_mfma_f32_16x16x32_bf16 v[188:191], v[24:27], v[236:239], v[188:191]
    ds_read_b64_tr_b16 v[20:21], v91 offset:36864
    v_mfma_f32_16x16x32_bf16 v[184:187], v[24:27], v[232:235], v[184:187]
    ds_read_b64_tr_b16 v[22:23], v91 offset:37632
    v_mfma_f32_16x16x32_bf16 v[180:183], v[24:27], v[228:231], v[180:183]
    v_mfma_f32_16x16x32_bf16 v[176:179], v[24:27], v[224:227], v[176:179]
    s_waitcnt lgkmcnt(4)
    v_mfma_f32_16x16x32_bf16 v[128:131], v[12:15], v[240:243], v[128:131]
    ds_read_b64_tr_b16 v[24:25], v91 offset:39936
    v_mfma_f32_16x16x32_bf16 v[132:135], v[12:15], v[244:247], v[132:135]
    ds_read_b64_tr_b16 v[26:27], v91 offset:40704
    v_mfma_f32_16x16x32_bf16 v[136:139], v[12:15], v[248:251], v[136:139]
    v_mfma_f32_16x16x32_bf16 v[140:143], v[12:15], v[252:255], v[140:143]
    s_waitcnt lgkmcnt(4)
    v_mfma_f32_16x16x32_bf16 v[156:159], v[16:19], v[252:255], v[156:159]
    s_barrier
    ds_read_b128 v[224:227], v88 offset:16384
    v_mfma_f32_16x16x32_bf16 v[152:155], v[16:19], v[248:251], v[152:155]
    ds_read_b64_tr_b16 v[12:13], v90 offset:0
    v_mfma_f32_16x16x32_bf16 v[148:151], v[16:19], v[244:247], v[148:151]
    ds_read_b64_tr_b16 v[14:15], v90 offset:768
    v_mfma_f32_16x16x32_bf16 v[144:147], v[16:19], v[240:243], v[144:147]
    ds_read_b128 v[228:231], v88 offset:18432
    s_waitcnt lgkmcnt(6)
    v_mfma_f32_16x16x32_bf16 v[160:163], v[20:23], v[240:243], v[160:163]
    ds_read_b128 v[232:235], v88 offset:20480
    v_mfma_f32_16x16x32_bf16 v[164:167], v[20:23], v[244:247], v[164:167]
    ds_read_b128 v[236:239], v88 offset:22528
    v_mfma_f32_16x16x32_bf16 v[168:171], v[20:23], v[248:251], v[168:171]
    ds_read_b64_tr_b16 v[16:17], v90 offset:3072
    v_mfma_f32_16x16x32_bf16 v[172:175], v[20:23], v[252:255], v[172:175]
    ds_read_b64_tr_b16 v[18:19], v90 offset:3840
    s_waitcnt lgkmcnt(8)
    v_mfma_f32_16x16x32_bf16 v[188:191], v[24:27], v[252:255], v[188:191]
    ds_read_b64_tr_b16 v[20:21], v91 offset:0
    v_mfma_f32_16x16x32_bf16 v[184:187], v[24:27], v[248:251], v[184:187]
    ds_read_b64_tr_b16 v[22:23], v91 offset:768
    v_mfma_f32_16x16x32_bf16 v[180:183], v[24:27], v[244:247], v[180:183]
    v_mfma_f32_16x16x32_bf16 v[176:179], v[24:27], v[240:243], v[176:179]
    s_waitcnt lgkmcnt(4)
    v_mfma_f32_16x16x32_bf16 v[128:131], v[12:15], v[224:227], v[128:131]
    ds_read_b64_tr_b16 v[24:25], v91 offset:3072
    v_mfma_f32_16x16x32_bf16 v[132:135], v[12:15], v[228:231], v[132:135]
    ds_read_b64_tr_b16 v[26:27], v91 offset:3840
    v_mfma_f32_16x16x32_bf16 v[136:139], v[12:15], v[232:235], v[136:139]
    ds_read_b128 v[240:243], v89 offset:16384
    v_mfma_f32_16x16x32_bf16 v[140:143], v[12:15], v[236:239], v[140:143]
    ds_read_b128 v[244:247], v89 offset:18432
    s_waitcnt lgkmcnt(6)
    v_mfma_f32_16x16x32_bf16 v[156:159], v[16:19], v[236:239], v[156:159]
    s_barrier
    ds_read_b64_tr_b16 v[12:13], v90 offset:12288
    v_mfma_f32_16x16x32_bf16 v[152:155], v[16:19], v[232:235], v[152:155]
    ds_read_b64_tr_b16 v[14:15], v90 offset:13056
    v_mfma_f32_16x16x32_bf16 v[148:151], v[16:19], v[228:231], v[148:151]
    ds_read_b128 v[248:251], v89 offset:20480
    v_mfma_f32_16x16x32_bf16 v[144:147], v[16:19], v[224:227], v[144:147]
    ds_read_b128 v[252:255], v89 offset:22528
    s_waitcnt lgkmcnt(8)
    v_mfma_f32_16x16x32_bf16 v[160:163], v[20:23], v[224:227], v[160:163]
    ds_read_b64_tr_b16 v[16:17], v90 offset:15360
    v_mfma_f32_16x16x32_bf16 v[164:167], v[20:23], v[228:231], v[164:167]
    ds_read_b64_tr_b16 v[18:19], v90 offset:16128
    v_mfma_f32_16x16x32_bf16 v[168:171], v[20:23], v[232:235], v[168:171]
    v_mfma_f32_16x16x32_bf16 v[172:175], v[20:23], v[236:239], v[172:175]
    s_waitcnt lgkmcnt(8)
    v_mfma_f32_16x16x32_bf16 v[188:191], v[24:27], v[236:239], v[188:191]
    ds_read_b64_tr_b16 v[20:21], v91 offset:12288
    v_mfma_f32_16x16x32_bf16 v[184:187], v[24:27], v[232:235], v[184:187]
    ds_read_b64_tr_b16 v[22:23], v91 offset:13056
    v_mfma_f32_16x16x32_bf16 v[180:183], v[24:27], v[228:231], v[180:183]
    v_mfma_f32_16x16x32_bf16 v[176:179], v[24:27], v[224:227], v[176:179]
    s_waitcnt lgkmcnt(4)
    v_mfma_f32_16x16x32_bf16 v[128:131], v[12:15], v[240:243], v[128:131]
    ds_read_b64_tr_b16 v[24:25], v91 offset:15360
    v_mfma_f32_16x16x32_bf16 v[132:135], v[12:15], v[244:247], v[132:135]
    ds_read_b64_tr_b16 v[26:27], v91 offset:16128
    v_mfma_f32_16x16x32_bf16 v[136:139], v[12:15], v[248:251], v[136:139]
    v_mfma_f32_16x16x32_bf16 v[140:143], v[12:15], v[252:255], v[140:143]
    s_waitcnt lgkmcnt(4)
    v_mfma_f32_16x16x32_bf16 v[156:159], v[16:19], v[252:255], v[156:159]
    s_barrier
    ds_read_b128 v[224:227], v88 offset:32768
    v_mfma_f32_16x16x32_bf16 v[152:155], v[16:19], v[248:251], v[152:155]
    ds_read_b64_tr_b16 v[12:13], v90 offset:24576
    v_mfma_f32_16x16x32_bf16 v[148:151], v[16:19], v[244:247], v[148:151]
    ds_read_b64_tr_b16 v[14:15], v90 offset:25344
    v_mfma_f32_16x16x32_bf16 v[144:147], v[16:19], v[240:243], v[144:147]
    ds_read_b128 v[228:231], v88 offset:34816
    s_waitcnt lgkmcnt(6)
    v_mfma_f32_16x16x32_bf16 v[160:163], v[20:23], v[240:243], v[160:163]
    ds_read_b128 v[232:235], v88 offset:36864
    v_mfma_f32_16x16x32_bf16 v[164:167], v[20:23], v[244:247], v[164:167]
    ds_read_b128 v[236:239], v88 offset:38912
    v_mfma_f32_16x16x32_bf16 v[168:171], v[20:23], v[248:251], v[168:171]
    ds_read_b64_tr_b16 v[16:17], v90 offset:27648
    v_mfma_f32_16x16x32_bf16 v[172:175], v[20:23], v[252:255], v[172:175]
    ds_read_b64_tr_b16 v[18:19], v90 offset:28416
    s_waitcnt lgkmcnt(8)
    v_mfma_f32_16x16x32_bf16 v[188:191], v[24:27], v[252:255], v[188:191]
    ds_read_b64_tr_b16 v[20:21], v91 offset:24576
    v_mfma_f32_16x16x32_bf16 v[184:187], v[24:27], v[248:251], v[184:187]
    ds_read_b64_tr_b16 v[22:23], v91 offset:25344
    v_mfma_f32_16x16x32_bf16 v[180:183], v[24:27], v[244:247], v[180:183]
    v_mfma_f32_16x16x32_bf16 v[176:179], v[24:27], v[240:243], v[176:179]
    s_waitcnt lgkmcnt(4)
    v_mfma_f32_16x16x32_bf16 v[128:131], v[12:15], v[224:227], v[128:131]
    ds_read_b64_tr_b16 v[24:25], v91 offset:27648
    v_mfma_f32_16x16x32_bf16 v[132:135], v[12:15], v[228:231], v[132:135]
    ds_read_b64_tr_b16 v[26:27], v91 offset:28416
    v_mfma_f32_16x16x32_bf16 v[136:139], v[12:15], v[232:235], v[136:139]
    ds_read_b128 v[240:243], v89 offset:32768
    v_mfma_f32_16x16x32_bf16 v[140:143], v[12:15], v[236:239], v[140:143]
    ds_read_b128 v[244:247], v89 offset:34816
    s_waitcnt lgkmcnt(6)
    v_mfma_f32_16x16x32_bf16 v[156:159], v[16:19], v[236:239], v[156:159]
    s_barrier
    ds_read_b64_tr_b16 v[12:13], v90 offset:36864
    v_mfma_f32_16x16x32_bf16 v[152:155], v[16:19], v[232:235], v[152:155]
    ds_read_b64_tr_b16 v[14:15], v90 offset:37632
    v_mfma_f32_16x16x32_bf16 v[148:151], v[16:19], v[228:231], v[148:151]
    ds_read_b128 v[248:251], v89 offset:36864
    v_mfma_f32_16x16x32_bf16 v[144:147], v[16:19], v[224:227], v[144:147]
    ds_read_b128 v[252:255], v89 offset:38912
    s_waitcnt lgkmcnt(8)
    v_mfma_f32_16x16x32_bf16 v[160:163], v[20:23], v[224:227], v[160:163]
    ds_read_b64_tr_b16 v[16:17], v90 offset:39936
    v_mfma_f32_16x16x32_bf16 v[164:167], v[20:23], v[228:231], v[164:167]
    ds_read_b64_tr_b16 v[18:19], v90 offset:40704
    v_mfma_f32_16x16x32_bf16 v[168:171], v[20:23], v[232:235], v[168:171]
    v_mfma_f32_16x16x32_bf16 v[172:175], v[20:23], v[236:239], v[172:175]
    s_waitcnt lgkmcnt(8)
    v_mfma_f32_16x16x32_bf16 v[188:191], v[24:27], v[236:239], v[188:191]
    ds_read_b64_tr_b16 v[20:21], v91 offset:36864
    v_mfma_f32_16x16x32_bf16 v[184:187], v[24:27], v[232:235], v[184:187]
    ds_read_b64_tr_b16 v[22:23], v91 offset:37632
    v_mfma_f32_16x16x32_bf16 v[180:183], v[24:27], v[228:231], v[180:183]
    v_mfma_f32_16x16x32_bf16 v[176:179], v[24:27], v[224:227], v[176:179]
    s_waitcnt lgkmcnt(4)
    v_mfma_f32_16x16x32_bf16 v[128:131], v[12:15], v[240:243], v[128:131]
    ds_read_b64_tr_b16 v[24:25], v91 offset:39936
    v_mfma_f32_16x16x32_bf16 v[132:135], v[12:15], v[244:247], v[132:135]
    ds_read_b64_tr_b16 v[26:27], v91 offset:40704
    v_mfma_f32_16x16x32_bf16 v[136:139], v[12:15], v[248:251], v[136:139]
    v_mfma_f32_16x16x32_bf16 v[140:143], v[12:15], v[252:255], v[140:143]
    s_waitcnt lgkmcnt(4)
    v_mfma_f32_16x16x32_bf16 v[156:159], v[16:19], v[252:255], v[156:159]
    s_barrier
    ds_read_b128 v[224:227], v88 offset:0
    v_mfma_f32_16x16x32_bf16 v[152:155], v[16:19], v[248:251], v[152:155]
    ds_read_b64_tr_b16 v[12:13], v90 offset:0
    v_mfma_f32_16x16x32_bf16 v[148:151], v[16:19], v[244:247], v[148:151]
    ds_read_b64_tr_b16 v[14:15], v90 offset:768
    v_mfma_f32_16x16x32_bf16 v[144:147], v[16:19], v[240:243], v[144:147]
    ds_read_b128 v[228:231], v88 offset:2048
    s_waitcnt lgkmcnt(6)
    v_mfma_f32_16x16x32_bf16 v[160:163], v[20:23], v[240:243], v[160:163]
    ds_read_b128 v[232:235], v88 offset:4096
    v_mfma_f32_16x16x32_bf16 v[164:167], v[20:23], v[244:247], v[164:167]
    ds_read_b128 v[236:239], v88 offset:6144
    v_mfma_f32_16x16x32_bf16 v[168:171], v[20:23], v[248:251], v[168:171]
    ds_read_b64_tr_b16 v[16:17], v90 offset:3072
    v_mfma_f32_16x16x32_bf16 v[172:175], v[20:23], v[252:255], v[172:175]
    ds_read_b64_tr_b16 v[18:19], v90 offset:3840
    s_waitcnt lgkmcnt(8)
    v_mfma_f32_16x16x32_bf16 v[188:191], v[24:27], v[252:255], v[188:191]
    ds_read_b64_tr_b16 v[20:21], v91 offset:0
    v_mfma_f32_16x16x32_bf16 v[184:187], v[24:27], v[248:251], v[184:187]
    ds_read_b64_tr_b16 v[22:23], v91 offset:768
    v_mfma_f32_16x16x32_bf16 v[180:183], v[24:27], v[244:247], v[180:183]
    v_mfma_f32_16x16x32_bf16 v[176:179], v[24:27], v[240:243], v[176:179]
    s_waitcnt lgkmcnt(4)
    v_mfma_f32_16x16x32_bf16 v[128:131], v[12:15], v[224:227], v[128:131]
    ds_read_b64_tr_b16 v[24:25], v91 offset:3072
    v_mfma_f32_16x16x32_bf16 v[132:135], v[12:15], v[228:231], v[132:135]
    ds_read_b64_tr_b16 v[26:27], v91 offset:3840
    v_mfma_f32_16x16x32_bf16 v[136:139], v[12:15], v[232:235], v[136:139]
    ds_read_b128 v[240:243], v89 offset:0
    v_mfma_f32_16x16x32_bf16 v[140:143], v[12:15], v[236:239], v[140:143]
    ds_read_b128 v[244:247], v89 offset:2048
    s_waitcnt lgkmcnt(6)
    v_mfma_f32_16x16x32_bf16 v[156:159], v[16:19], v[236:239], v[156:159]
    s_barrier
    ds_read_b64_tr_b16 v[12:13], v90 offset:12288
    v_mfma_f32_16x16x32_bf16 v[152:155], v[16:19], v[232:235], v[152:155]
    ds_read_b64_tr_b16 v[14:15], v90 offset:13056
    v_mfma_f32_16x16x32_bf16 v[148:151], v[16:19], v[228:231], v[148:151]
    ds_read_b128 v[248:251], v89 offset:4096
    v_mfma_f32_16x16x32_bf16 v[144:147], v[16:19], v[224:227], v[144:147]
    ds_read_b128 v[252:255], v89 offset:6144
    s_waitcnt lgkmcnt(8)
    v_mfma_f32_16x16x32_bf16 v[160:163], v[20:23], v[224:227], v[160:163]
    ds_read_b64_tr_b16 v[16:17], v90 offset:15360
    v_mfma_f32_16x16x32_bf16 v[164:167], v[20:23], v[228:231], v[164:167]
    ds_read_b64_tr_b16 v[18:19], v90 offset:16128
    v_mfma_f32_16x16x32_bf16 v[168:171], v[20:23], v[232:235], v[168:171]
    v_mfma_f32_16x16x32_bf16 v[172:175], v[20:23], v[236:239], v[172:175]
    s_waitcnt lgkmcnt(8)
    v_mfma_f32_16x16x32_bf16 v[188:191], v[24:27], v[236:239], v[188:191]
    ds_read_b64_tr_b16 v[20:21], v91 offset:12288
    v_mfma_f32_16x16x32_bf16 v[184:187], v[24:27], v[232:235], v[184:187]
    ds_read_b64_tr_b16 v[22:23], v91 offset:13056
    v_mfma_f32_16x16x32_bf16 v[180:183], v[24:27], v[228:231], v[180:183]
    v_mfma_f32_16x16x32_bf16 v[176:179], v[24:27], v[224:227], v[176:179]
    s_waitcnt lgkmcnt(4)
    v_mfma_f32_16x16x32_bf16 v[128:131], v[12:15], v[240:243], v[128:131]
    ds_read_b64_tr_b16 v[24:25], v91 offset:15360
    v_mfma_f32_16x16x32_bf16 v[132:135], v[12:15], v[244:247], v[132:135]
    ds_read_b64_tr_b16 v[26:27], v91 offset:16128
    v_mfma_f32_16x16x32_bf16 v[136:139], v[12:15], v[248:251], v[136:139]
    v_mfma_f32_16x16x32_bf16 v[140:143], v[12:15], v[252:255], v[140:143]
    s_waitcnt lgkmcnt(4)
    v_mfma_f32_16x16x32_bf16 v[156:159], v[16:19], v[252:255], v[156:159]
    s_barrier
    ds_read_b128 v[224:227], v88 offset:16384
    v_mfma_f32_16x16x32_bf16 v[152:155], v[16:19], v[248:251], v[152:155]
    ds_read_b64_tr_b16 v[12:13], v90 offset:24576
    v_mfma_f32_16x16x32_bf16 v[148:151], v[16:19], v[244:247], v[148:151]
    ds_read_b64_tr_b16 v[14:15], v90 offset:25344
    v_mfma_f32_16x16x32_bf16 v[144:147], v[16:19], v[240:243], v[144:147]
    ds_read_b128 v[228:231], v88 offset:18432
    s_waitcnt lgkmcnt(6)
    v_mfma_f32_16x16x32_bf16 v[160:163], v[20:23], v[240:243], v[160:163]
    ds_read_b128 v[232:235], v88 offset:20480
    v_mfma_f32_16x16x32_bf16 v[164:167], v[20:23], v[244:247], v[164:167]
    ds_read_b128 v[236:239], v88 offset:22528
    v_mfma_f32_16x16x32_bf16 v[168:171], v[20:23], v[248:251], v[168:171]
    ds_read_b64_tr_b16 v[16:17], v90 offset:27648
    v_mfma_f32_16x16x32_bf16 v[172:175], v[20:23], v[252:255], v[172:175]
    ds_read_b64_tr_b16 v[18:19], v90 offset:28416
    s_waitcnt lgkmcnt(8)
    v_mfma_f32_16x16x32_bf16 v[188:191], v[24:27], v[252:255], v[188:191]
    ds_read_b64_tr_b16 v[20:21], v91 offset:24576
    v_mfma_f32_16x16x32_bf16 v[184:187], v[24:27], v[248:251], v[184:187]
    ds_read_b64_tr_b16 v[22:23], v91 offset:25344
    v_mfma_f32_16x16x32_bf16 v[180:183], v[24:27], v[244:247], v[180:183]
    v_mfma_f32_16x16x32_bf16 v[176:179], v[24:27], v[240:243], v[176:179]
    s_waitcnt lgkmcnt(4)
    v_mfma_f32_16x16x32_bf16 v[128:131], v[12:15], v[224:227], v[128:131]
    ds_read_b64_tr_b16 v[24:25], v91 offset:27648
    v_mfma_f32_16x16x32_bf16 v[132:135], v[12:15], v[228:231], v[132:135]
    ds_read_b64_tr_b16 v[26:27], v91 offset:28416
    v_mfma_f32_16x16x32_bf16 v[136:139], v[12:15], v[232:235], v[136:139]
    ds_read_b128 v[240:243], v89 offset:16384
    v_mfma_f32_16x16x32_bf16 v[140:143], v[12:15], v[236:239], v[140:143]
    ds_read_b128 v[244:247], v89 offset:18432
    s_waitcnt lgkmcnt(6)
    v_mfma_f32_16x16x32_bf16 v[156:159], v[16:19], v[236:239], v[156:159]
    s_barrier
    ds_read_b64_tr_b16 v[12:13], v90 offset:36864
    v_mfma_f32_16x16x32_bf16 v[152:155], v[16:19], v[232:235], v[152:155]
    ds_read_b64_tr_b16 v[14:15], v90 offset:37632
    v_mfma_f32_16x16x32_bf16 v[148:151], v[16:19], v[228:231], v[148:151]
    ds_read_b128 v[248:251], v89 offset:20480
    v_mfma_f32_16x16x32_bf16 v[144:147], v[16:19], v[224:227], v[144:147]
    ds_read_b128 v[252:255], v89 offset:22528
    s_waitcnt lgkmcnt(8)
    v_mfma_f32_16x16x32_bf16 v[160:163], v[20:23], v[224:227], v[160:163]
    ds_read_b64_tr_b16 v[16:17], v91 offset:36864
    v_mfma_f32_16x16x32_bf16 v[164:167], v[20:23], v[228:231], v[164:167]
    ds_read_b64_tr_b16 v[18:19], v91 offset:37632
    v_mfma_f32_16x16x32_bf16 v[168:171], v[20:23], v[232:235], v[168:171]
    v_mfma_f32_16x16x32_bf16 v[172:175], v[20:23], v[236:239], v[172:175]
    s_waitcnt lgkmcnt(8)
    v_mfma_f32_16x16x32_bf16 v[188:191], v[24:27], v[236:239], v[188:191]
    ds_read_b64_tr_b16 v[20:21], v90 offset:39936
    v_mfma_f32_16x16x32_bf16 v[184:187], v[24:27], v[232:235], v[184:187]
    ds_read_b64_tr_b16 v[22:23], v90 offset:40704
    v_mfma_f32_16x16x32_bf16 v[180:183], v[24:27], v[228:231], v[180:183]
    v_mfma_f32_16x16x32_bf16 v[176:179], v[24:27], v[224:227], v[176:179]
    s_waitcnt lgkmcnt(4)
    v_mfma_f32_16x16x32_bf16 v[128:131], v[12:15], v[240:243], v[128:131]
    ds_read_b64_tr_b16 v[24:25], v91 offset:39936
    v_mfma_f32_16x16x32_bf16 v[132:135], v[12:15], v[244:247], v[132:135]
    ds_read_b64_tr_b16 v[26:27], v91 offset:40704
    v_mfma_f32_16x16x32_bf16 v[136:139], v[12:15], v[248:251], v[136:139]
    v_mfma_f32_16x16x32_bf16 v[140:143], v[12:15], v[252:255], v[140:143]
    s_waitcnt lgkmcnt(4)
    v_mfma_f32_16x16x32_bf16 v[172:175], v[16:19], v[252:255], v[172:175]
    v_mfma_f32_16x16x32_bf16 v[168:171], v[16:19], v[248:251], v[168:171]
    v_mul_f32 v224, s52, v128
    v_mul_f32 v225, s52, v129
    v_mfma_f32_16x16x32_bf16 v[164:167], v[16:19], v[244:247], v[164:167]
    v_mul_f32 v226, s52, v130
    v_mul_f32 v227, s52, v131
    v_mfma_f32_16x16x32_bf16 v[160:163], v[16:19], v[240:243], v[160:163]
    v_exp_f32 v224, v224
    s_waitcnt lgkmcnt(2)
    v_mfma_f32_16x16x32_bf16 v[144:147], v[20:23], v[240:243], v[144:147]
    v_exp_f32 v225, v225
    v_mfma_f32_16x16x32_bf16 v[148:151], v[20:23], v[244:247], v[148:151]
    v_exp_f32 v226, v226
    v_mfma_f32_16x16x32_bf16 v[152:155], v[20:23], v[248:251], v[152:155]
    v_exp_f32 v227, v227
    v_mfma_f32_16x16x32_bf16 v[156:159], v[20:23], v[252:255], v[156:159]
    v_mul_f32 v228, s52, v132
    v_mul_f32 v229, s52, v133
    s_waitcnt lgkmcnt(0)
    v_mfma_f32_16x16x32_bf16 v[188:191], v[24:27], v[252:255], v[188:191]
    v_mul_f32 v230, s52, v134
    v_mul_f32 v231, s52, v135
    v_mfma_f32_16x16x32_bf16 v[184:187], v[24:27], v[248:251], v[184:187]
    v_exp_f32 v228, v228
    v_mfma_f32_16x16x32_bf16 v[180:183], v[24:27], v[244:247], v[180:183]
    v_exp_f32 v229, v229
    v_mfma_f32_16x16x32_bf16 v[176:179], v[24:27], v[240:243], v[176:179]
    v_exp_f32 v230, v230
    s_nop 0
    v_exp_f32 v231, v231
    v_pk_mul_f32 v[232:233], v[136:137], s[52:53]
    v_pk_mul_f32 v[234:235], v[138:139], s[52:53]
    v_exp_f32 v232, v232
    v_exp_f32 v233, v233
    v_exp_f32 v234, v234
    v_exp_f32 v235, v235
    v_pk_mul_f32 v[236:237], v[140:141], s[52:53]
    v_pk_mul_f32 v[238:239], v[142:143], s[52:53]
    v_exp_f32 v236, v236
    v_exp_f32 v237, v237
    v_exp_f32 v238, v238
    v_exp_f32 v239, v239
    s_barrier
    ds_read_b128 v[96:99], v126 offset:32768
    ds_read_b128 v[100:103], v126 offset:33024
    v_mul_f32 v28, s52, v160
    v_mul_f32 v29, s52, v161
    v_mul_f32 v30, s52, v162
    v_mul_f32 v31, s52, v163
    v_exp_f32 v28, v28
    v_exp_f32 v29, v29
    v_exp_f32 v30, v30
    v_exp_f32 v31, v31
    v_mul_f32 v32, s52, v164
    v_mul_f32 v33, s52, v165
    v_mul_f32 v34, s52, v166
    v_mul_f32 v35, s52, v167
    v_exp_f32 v32, v32
    v_exp_f32 v33, v33
    v_exp_f32 v34, v34
    v_exp_f32 v35, v35
    v_mul_f32 v36, s52, v168
    v_mul_f32 v37, s52, v169
    v_mul_f32 v38, s52, v170
    v_mul_f32 v39, s52, v171
    v_exp_f32 v36, v36
    v_exp_f32 v37, v37
    v_exp_f32 v38, v38
    v_exp_f32 v39, v39
    v_mul_f32 v40, s52, v172
    v_mul_f32 v41, s52, v173
    v_mul_f32 v42, s52, v174
    v_mul_f32 v43, s52, v175
    v_exp_f32 v40, v40
    v_exp_f32 v41, v41
    v_exp_f32 v42, v42
    v_exp_f32 v43, v43
    s_waitcnt lgkmcnt(0)
    v_fma_f32 v224, v224, v96, v96
    v_fma_f32 v225, v225, v96, v96
    v_fma_f32 v226, v226, v96, v96
    v_fma_f32 v227, v227, v96, v96
    v_rcp_f32 v224, v224
    v_rcp_f32 v225, v225
    v_rcp_f32 v226, v226
    v_rcp_f32 v227, v227
    v_mul_f32 v224, v224, v128
    v_mul_f32 v225, v225, v129
    v_mul_f32 v226, v226, v130
    v_mul_f32 v227, v227, v131
    v_mul_f32 v224, v224, v144
    v_mul_f32 v225, v225, v145
    v_mul_f32 v226, v226, v146
    v_mul_f32 v227, v227, v147
    v_cvt_pk_bf16_f32 v128, v224, v225
    v_cvt_pk_bf16_f32 v129, v226, v227
    v_fma_f32 v228, v228, v98, v98
    v_fma_f32 v229, v229, v98, v98
    v_fma_f32 v230, v230, v98, v98
    v_fma_f32 v231, v231, v98, v98
    v_rcp_f32 v228, v228
    v_rcp_f32 v229, v229
    v_rcp_f32 v230, v230
    v_rcp_f32 v231, v231
    v_mul_f32 v228, v228, v132
    v_mul_f32 v229, v229, v133
    v_mul_f32 v230, v230, v134
    v_mul_f32 v231, v231, v135
    v_mul_f32 v228, v228, v148
    v_mul_f32 v229, v229, v149
    v_mul_f32 v230, v230, v150
    v_mul_f32 v231, v231, v151
    v_cvt_pk_bf16_f32 v130, v228, v229
    v_cvt_pk_bf16_f32 v131, v230, v231
    v_fma_f32 v232, v232, v100, v100
    v_fma_f32 v233, v233, v100, v100
    v_fma_f32 v234, v234, v100, v100
    v_fma_f32 v235, v235, v100, v100
    v_permlane16_swap_b32 v128, v130
    v_permlane16_swap_b32 v129, v131
    v_rcp_f32 v232, v232
    v_rcp_f32 v233, v233
    v_rcp_f32 v234, v234
    v_rcp_f32 v235, v235
    v_mul_f32 v232, v232, v136
    v_mul_f32 v233, v233, v137
    v_mul_f32 v234, v234, v138
    v_mul_f32 v235, v235, v139
    v_mul_f32 v232, v232, v152
    v_mul_f32 v233, v233, v153
    v_mul_f32 v234, v234, v154
    v_mul_f32 v235, v235, v155
    v_cvt_pk_bf16_f32 v136, v232, v233
    v_cvt_pk_bf16_f32 v137, v234, v235
    v_fma_f32 v236, v236, v102, v102
    v_fma_f32 v237, v237, v102, v102
    v_fma_f32 v238, v238, v102, v102
    v_fma_f32 v239, v239, v102, v102
    v_rcp_f32 v236, v236
    v_rcp_f32 v237, v237
    v_rcp_f32 v238, v238
    v_rcp_f32 v239, v239
    v_pk_mul_f32 v[236:237], v[236:237], v[140:141]
    v_pk_mul_f32 v[238:239], v[238:239], v[142:143]
    v_pk_mul_f32 v[236:237], v[236:237], v[156:157]
    v_pk_mul_f32 v[238:239], v[238:239], v[158:159]
    v_cvt_pk_bf16_f32 v138, v236, v237
    v_cvt_pk_bf16_f32 v139, v238, v239
    v_pk_fma_f32 v[28:29], v[28:29], v[96:97], v[96:97]
    v_pk_fma_f32 v[30:31], v[30:31], v[96:97], v[96:97]
    v_permlane16_swap_b32 v136, v138
    v_permlane16_swap_b32 v137, v139
    v_rcp_f32 v28, v28
    v_rcp_f32 v29, v29
    v_rcp_f32 v30, v30
    v_rcp_f32 v31, v31
    v_pk_mul_f32 v[28:29], v[28:29], v[160:161]
    v_pk_mul_f32 v[30:31], v[30:31], v[162:163]
    v_pk_mul_f32 v[28:29], v[28:29], v[176:177]
    v_pk_mul_f32 v[30:31], v[30:31], v[178:179]
    v_cvt_pk_bf16_f32 v160, v28, v29
    v_cvt_pk_bf16_f32 v161, v30, v31
    v_pk_fma_f32 v[32:33], v[32:33], v[98:99], v[98:99]
    v_pk_fma_f32 v[34:35], v[34:35], v[98:99], v[98:99]
    v_rcp_f32 v32, v32
    v_rcp_f32 v33, v33
    v_rcp_f32 v34, v34
    buffer_store_dwordx4 v[128:131], v2, s[28:31], s65 offen offset:0 sc1
    v_rcp_f32 v35, v35
    v_pk_mul_f32 v[32:33], v[32:33], v[164:165]
    v_pk_mul_f32 v[34:35], v[34:35], v[166:167]
    v_pk_mul_f32 v[32:33], v[32:33], v[180:181]
    v_pk_mul_f32 v[34:35], v[34:35], v[182:183]
    v_cvt_pk_bf16_f32 v162, v32, v33
    v_cvt_pk_bf16_f32 v163, v34, v35
    v_pk_fma_f32 v[36:37], v[36:37], v[100:101], v[100:101]
    v_pk_fma_f32 v[38:39], v[38:39], v[100:101], v[100:101]
    v_permlane16_swap_b32 v160, v162
    v_permlane16_swap_b32 v161, v163
    v_rcp_f32 v36, v36
    buffer_store_dwordx4 v[136:139], v2, s[28:31], s66 offen offset:0 sc1
    v_rcp_f32 v37, v37
    v_rcp_f32 v38, v38
    s_barrier
    ds_read_b128 v[84:87], v122
    ds_read_b128 v[60:63], v4 offset:32768
    v_rcp_f32 v39, v39
    v_mul_f32 v36, v36, v168
    v_mul_f32 v37, v37, v169
    s_mov_b32 s54, 0x0000ffff
    s_mov_b32 s55, 0x0000ffff
    ds_read_b128 v[64:67], v4 offset:34816
    v_mul_f32 v38, v38, v170
    v_mul_f32 v39, v39, v171
    v_mul_f32 v36, v36, v184
    v_mul_f32 v37, v37, v185
    s_mov_b64 exec, s[54:55]
    ds_read_b128 v[68:71], v5 offset:32768
    ds_read_b128 v[72:75], v5 offset:33280
    s_mov_b64 exec, -1
    v_mul_f32 v38, v38, v186
    v_mul_f32 v39, v39, v187
    v_cvt_pk_bf16_f32 v168, v36, v37
    v_cvt_pk_bf16_f32 v169, v38, v39
    v_fma_f32 v40, v40, v102, v102
    v_fma_f32 v41, v41, v102, v102
    v_fma_f32 v42, v42, v102, v102
    v_fma_f32 v43, v43, v102, v102
    v_rcp_f32 v40, v40
    buffer_store_dwordx4 v[160:163], v2, s[28:31], s65 offen offset:1024 sc1
    v_rcp_f32 v41, v41
    s_waitcnt lgkmcnt(3)
    v_mfma_f32_32x32x16_bf16 v[12:27], v[60:63], v[84:87], 0
    v_rcp_f32 v42, v42
    v_rcp_f32 v43, v43
    v_mul_f32 v40, v40, v172
    v_mul_f32 v41, v41, v173
    v_mul_f32 v42, v42, v174
    v_mul_f32 v43, v43, v175
    v_mul_f32 v40, v40, v188
    v_mul_f32 v41, v41, v189
    v_mul_f32 v42, v42, v190
    v_mul_f32 v43, v43, v191
    v_cvt_pk_bf16_f32 v170, v40, v41
    v_cvt_pk_bf16_f32 v171, v42, v43
    s_nop 1
    v_permlane16_swap_b32 v168, v170
    v_permlane16_swap_b32 v169, v171
    buffer_store_dwordx4 v[168:171], v2, s[28:31], s66 offen offset:1024 sc1
    s_branch LA_join
LA_kv2:
    v_and_b32 v104, 31, v1
    v_lshlrev_b32 v105, 7, v104
    s_lshl_b32 s8, s6, 12
    v_add_u32 v105, s8, v105
    v_bfe_u32 v104, v1, 1, 3
    v_xor_b32 v104, v104, v106
    v_lshl_add_u32 v88, v104, 4, v105
    v_xor_b32 v89, 32, v88
    v_xor_b32 v90, 64, v88
    v_xor_b32 v91, 96, v88
    s_lshl_b32 s8, s7, 13
    s_add_u32 s8, s8, 0x10000
    v_lshlrev_b32 v92, 1, v120
    v_lshl_add_u32 v92, v106, 8, v92
    v_add_u32 v92, s8, v92
    v_add_u32 v94, 0x20000, v94
    s_mov_b32 s8, 0x10800
    v_lshlrev_b32 v93, 4, v106
    v_add_u32 v93, s8, v93
    s_barrier
    s_bfe_u32 s70, s62, 0x30008
    s_add_u32 m0, s63, 32768
    s_lshl_b32 s69, s70, 7
    buffer_load_dwordx4 v96, s[12:15], s69 offen lds
    s_add_u32 m0, s64, 32768
    s_lshl_b32 s70, s70, s71
    buffer_load_dwordx4 v98, s[16:19], s70 offen lds
    s_add_u32 m0, s63, 33792
    s_nop 0
    buffer_load_dwordx4 v97, s[12:15], s69 offen lds
    s_barrier
    s_bfe_u32 s70, s62, 0x3000c
    s_add_u32 m0, s63, 49152
    s_lshl_b32 s69, s70, 7
    buffer_load_dwordx4 v96, s[12:15], s69 offen lds
    s_add_u32 m0, s64, 49152
    s_lshl_b32 s70, s70, s71
    buffer_load_dwordx4 v98, s[16:19], s70 offen lds
    s_add_u32 m0, s63, 50176
    s_nop 0
    buffer_load_dwordx4 v97, s[12:15], s69 offen lds
    s_waitcnt vmcnt(9)
    s_barrier
    s_cmp_eq_u32 s7, 0
    s_cbranch_scc0 LA_v
    ds_read_b128 v[128:131], v88 offset:0
    ds_read_b64_tr_b16 v[12:13], v92 offset:0
    ds_read_b64_tr_b16 v[14:15], v92 offset:128
    s_mov_b64 exec, s[54:55]
    ds_read_b128 v[12:15], v93 offset:0
    s_mov_b64 exec, -1
    ds_read_b128 v[132:135], v89 offset:0
    ds_read_b64_tr_b16 v[16:17], v92 offset:512
    ds_read_b64_tr_b16 v[18:19], v92 offset:640
    s_mov_b64 exec, s[54:55]
    ds_read_b128 v[16:19], v93 offset:32
    s_mov_b64 exec, -1
    ds_read_b128 v[136:139], v90 offset:0
    ds_read_b64_tr_b16 v[20:21], v92 offset:1024
    ds_read_b64_tr_b16 v[22:23], v92 offset:1152
    s_mov_b64 exec, s[54:55]
    ds_read_b128 v[20:23], v93 offset:64
    s_mov_b64 exec, -1
    s_waitcnt lgkmcnt(8)
    v_mfma_f32_32x32x16_bf16 v[28:43], v[12:15], v[128:131], 0
    ds_read_b128 v[140:143], v91 offset:0
    ds_read_b64_tr_b16 v[12:13], v92 offset:1536
    ds_read_b64_tr_b16 v[14:15], v92 offset:1664
    s_mov_b64 exec, s[54:55]
    ds_read_b128 v[12:15], v93 offset:96
    s_mov_b64 exec, -1
    s_waitcnt lgkmcnt(8)
    v_mfma_f32_32x32x16_bf16 v[28:43], v[16:19], v[132:135], v[28:43]
    s_waitcnt lgkmcnt(4)
    v_mfma_f32_32x32x16_bf16 v[28:43], v[20:23], v[136:139], v[28:43]
    s_waitcnt vmcnt(6) lgkmcnt(0)
    s_barrier
    ds_read_b128 v[144:147], v88 offset:16384
    ds_read_b64_tr_b16 v[16:17], v92 offset:16384
    ds_read_b64_tr_b16 v[18:19], v92 offset:16512
    s_mov_b64 exec, s[54:55]
    ds_read_b128 v[16:19], v93 offset:16384
    s_mov_b64 exec, -1
    s_bfe_u32 s70, s62, 0x30010
    s_add_u32 m0, s63, 0
    s_lshl_b32 s69, s70, 7
    buffer_load_dwordx4 v96, s[12:15], s69 offen lds
    ds_read_b128 v[148:151], v89 offset:16384
    ds_read_b64_tr_b16 v[20:21], v92 offset:16896
    ds_read_b64_tr_b16 v[22:23], v92 offset:17024
    s_mov_b64 exec, s[54:55]
    ds_read_b128 v[20:23], v93 offset:16416
    s_mov_b64 exec, -1
    s_waitcnt lgkmcnt(8)
    v_mfma_f32_32x32x16_bf16 v[28:43], v[12:15], v[140:143], v[28:43]
    s_add_u32 m0, s64, 0
    s_lshl_b32 s70, s70, s71
    buffer_load_dwordx4 v98, s[16:19], s70 offen lds
    ds_read_b128 v[152:155], v90 offset:16384
    ds_read_b64_tr_b16 v[12:13], v92 offset:17408
    ds_read_b64_tr_b16 v[14:15], v92 offset:17536
    s_mov_b64 exec, s[54:55]
    ds_read_b128 v[12:15], v93 offset:16448
    s_mov_b64 exec, -1
    s_waitcnt lgkmcnt(8)
    v_mfma_f32_32x32x16_bf16 v[28:43], v[16:19], v[144:147], v[28:43]
    s_add_u32 m0, s63, 1024
    s_nop 0
    buffer_load_dwordx4 v97, s[12:15], s69 offen lds
    ds_read_b128 v[156:159], v91 offset:16384
    ds_read_b64_tr_b16 v[16:17], v92 offset:17920
    ds_read_b64_tr_b16 v[18:19], v92 offset:18048
    s_mov_b64 exec, s[54:55]
    ds_read_b128 v[16:19], v93 offset:16480
    s_mov_b64 exec, -1
    s_waitcnt lgkmcnt(8)
    v_mfma_f32_32x32x16_bf16 v[28:43], v[20:23], v[148:151], v[28:43]
    s_waitcnt lgkmcnt(4)
    v_mfma_f32_32x32x16_bf16 v[28:43], v[12:15], v[152:155], v[28:43]
    s_waitcnt vmcnt(6) lgkmcnt(0)
    s_barrier
    ds_read_b128 v[160:163], v88 offset:32768
    ds_read_b64_tr_b16 v[20:21], v92 offset:32768
    ds_read_b64_tr_b16 v[22:23], v92 offset:32896
    s_mov_b64 exec, s[54:55]
    ds_read_b128 v[20:23], v93 offset:32768
    s_mov_b64 exec, -1
    s_bfe_u32 s70, s62, 0x30014
    s_add_u32 m0, s63, 16384
    s_lshl_b32 s69, s70, 7
    buffer_load_dwordx4 v96, s[12:15], s69 offen lds
    ds_read_b128 v[164:167], v89 offset:32768
    ds_read_b64_tr_b16 v[12:13], v92 offset:33280
    ds_read_b64_tr_b16 v[14:15], v92 offset:33408
    s_mov_b64 exec, s[54:55]
    ds_read_b128 v[12:15], v93 offset:32800
    s_mov_b64 exec, -1
    s_waitcnt lgkmcnt(8)
    v_mfma_f32_32x32x16_bf16 v[28:43], v[16:19], v[156:159], v[28:43]
    s_add_u32 m0, s64, 16384
    s_lshl_b32 s70, s70, s71
    buffer_load_dwordx4 v98, s[16:19], s70 offen lds
    ds_read_b128 v[168:171], v90 offset:32768
    ds_read_b64_tr_b16 v[16:17], v92 offset:33792
    ds_read_b64_tr_b16 v[18:19], v92 offset:33920
    s_mov_b64 exec, s[54:55]
    ds_read_b128 v[16:19], v93 offset:32832
    s_mov_b64 exec, -1
    s_waitcnt lgkmcnt(8)
    v_mfma_f32_32x32x16_bf16 v[28:43], v[20:23], v[160:163], v[28:43]
    s_add_u32 m0, s63, 17408
    s_nop 0
    buffer_load_dwordx4 v97, s[12:15], s69 offen lds
    ds_read_b128 v[172:175], v91 offset:32768
    ds_read_b64_tr_b16 v[20:21], v92 offset:34304
    ds_read_b64_tr_b16 v[22:23], v92 offset:34432
    s_mov_b64 exec, s[54:55]
    ds_read_b128 v[20:23], v93 offset:32864
    s_mov_b64 exec, -1
    s_waitcnt lgkmcnt(8)
    v_mfma_f32_32x32x16_bf16 v[28:43], v[12:15], v[164:167], v[28:43]
    s_waitcnt lgkmcnt(4)
    v_mfma_f32_32x32x16_bf16 v[28:43], v[16:19], v[168:171], v[28:43]
    s_waitcnt vmcnt(6) lgkmcnt(0)
    s_barrier
    ds_read_b128 v[176:179], v88 offset:49152
    ds_read_b64_tr_b16 v[12:13], v92 offset:49152
    ds_read_b64_tr_b16 v[14:15], v92 offset:49280
    s_mov_b64 exec, s[54:55]
    ds_read_b128 v[12:15], v93 offset:49152
    s_mov_b64 exec, -1
    s_bfe_u32 s70, s62, 0x30018
    s_add_u32 m0, s63, 32768
    s_lshl_b32 s69, s70, 7
    buffer_load_dwordx4 v96, s[12:15], s69 offen lds
    ds_read_b128 v[180:183], v89 offset:49152
    ds_read_b64_tr_b16 v[16:17], v92 offset:49664
    ds_read_b64_tr_b16 v[18:19], v92 offset:49792
    s_mov_b64 exec, s[54:55]
    ds_read_b128 v[16:19], v93 offset:49184
    s_mov_b64 exec, -1
    s_waitcnt lgkmcnt(8)
    v_mfma_f32_32x32x16_bf16 v[28:43], v[20:23], v[172:175], v[28:43]
    s_add_u32 m0, s64, 32768
    s_lshl_b32 s70, s70, s71
    buffer_load_dwordx4 v98, s[16:19], s70 offen lds
    ds_read_b128 v[184:187], v90 offset:49152
    ds_read_b64_tr_b16 v[20:21], v92 offset:50176
    ds_read_b64_tr_b16 v[22:23], v92 offset:50304
    s_mov_b64 exec, s[54:55]
    ds_read_b128 v[20:23], v93 offset:49216
    s_mov_b64 exec, -1
    s_waitcnt lgkmcnt(8)
    v_mfma_f32_32x32x16_bf16 v[28:43], v[12:15], v[176:179], v[28:43]
    s_add_u32 m0, s63, 33792
    s_nop 0
    buffer_load_dwordx4 v97, s[12:15], s69 offen lds
    ds_read_b128 v[188:191], v91 offset:49152
    ds_read_b64_tr_b16 v[12:13], v92 offset:50688
    ds_read_b64_tr_b16 v[14:15], v92 offset:50816
    s_mov_b64 exec, s[54:55]
    ds_read_b128 v[12:15], v93 offset:49248
    s_mov_b64 exec, -1
    s_waitcnt lgkmcnt(8)
    v_mfma_f32_32x32x16_bf16 v[28:43], v[16:19], v[180:183], v[28:43]
    s_waitcnt lgkmcnt(4)
    v_mfma_f32_32x32x16_bf16 v[28:43], v[20:23], v[184:187], v[28:43]
    s_waitcnt vmcnt(6) lgkmcnt(0)
    s_barrier
    ds_read_b128 v[192:195], v88 offset:0
    ds_read_b64_tr_b16 v[16:17], v92 offset:0
    ds_read_b64_tr_b16 v[18:19], v92 offset:128
    s_mov_b64 exec, s[54:55]
    ds_read_b128 v[16:19], v93 offset:0
    s_mov_b64 exec, -1
    s_bfe_u32 s70, s62, 0x3001c
    s_add_u32 m0, s63, 49152
    s_lshl_b32 s69, s70, 7
    buffer_load_dwordx4 v96, s[12:15], s69 offen lds
    ds_read_b128 v[196:199], v89 offset:0
    ds_read_b64_tr_b16 v[20:21], v92 offset:512
    ds_read_b64_tr_b16 v[22:23], v92 offset:640
    s_mov_b64 exec, s[54:55]
    ds_read_b128 v[20:23], v93 offset:32
    s_mov_b64 exec, -1
    s_waitcnt lgkmcnt(8)
    v_mfma_f32_32x32x16_bf16 v[28:43], v[12:15], v[188:191], v[28:43]
    s_add_u32 m0, s64, 49152
    s_lshl_b32 s70, s70, s71
    buffer_load_dwordx4 v98, s[16:19], s70 offen lds
    ds_read_b128 v[200:203], v90 offset:0
    ds_read_b64_tr_b16 v[12:13], v92 offset:1024
    ds_read_b64_tr_b16 v[14:15], v92 offset:1152
    s_mov_b64 exec, s[54:55]
    ds_read_b128 v[12:15], v93 offset:64
    s_mov_b64 exec, -1
    s_waitcnt lgkmcnt(8)
    v_mfma_f32_32x32x16_bf16 v[28:43], v[16:19], v[192:195], v[28:43]
    s_add_u32 m0, s63, 50176
    s_nop 0
    buffer_load_dwordx4 v97, s[12:15], s69 offen lds
    ds_read_b128 v[204:207], v91 offset:0
    ds_read_b64_tr_b16 v[16:17], v92 offset:1536
    ds_read_b64_tr_b16 v[18:19], v92 offset:1664
    s_mov_b64 exec, s[54:55]
    ds_read_b128 v[16:19], v93 offset:96
    s_mov_b64 exec, -1
    s_waitcnt lgkmcnt(8)
    v_mfma_f32_32x32x16_bf16 v[28:43], v[20:23], v[196:199], v[28:43]
    s_waitcnt lgkmcnt(4)
    v_mfma_f32_32x32x16_bf16 v[28:43], v[12:15], v[200:203], v[28:43]
    s_waitcnt vmcnt(6) lgkmcnt(0)
    s_barrier
    ds_read_b128 v[208:211], v88 offset:16384
    ds_read_b64_tr_b16 v[20:21], v92 offset:16384
    ds_read_b64_tr_b16 v[22:23], v92 offset:16512
    s_mov_b64 exec, s[54:55]
    ds_read_b128 v[20:23], v93 offset:16384
    s_mov_b64 exec, -1
    ds_read_b128 v[212:215], v89 offset:16384
    ds_read_b64_tr_b16 v[12:13], v92 offset:16896
    ds_read_b64_tr_b16 v[14:15], v92 offset:17024
    s_mov_b64 exec, s[54:55]
    ds_read_b128 v[12:15], v93 offset:16416
    s_mov_b64 exec, -1
    s_waitcnt lgkmcnt(8)
    v_mfma_f32_32x32x16_bf16 v[28:43], v[16:19], v[204:207], v[28:43]
    ds_read_b128 v[216:219], v90 offset:16384
    ds_read_b64_tr_b16 v[16:17], v92 offset:17408
    ds_read_b64_tr_b16 v[18:19], v92 offset:17536
    s_mov_b64 exec, s[54:55]
    ds_read_b128 v[16:19], v93 offset:16448
    s_mov_b64 exec, -1
    s_waitcnt lgkmcnt(8)
    v_mfma_f32_32x32x16_bf16 v[28:43], v[20:23], v[208:211], v[28:43]
    ds_read_b128 v[220:223], v91 offset:16384
    ds_read_b64_tr_b16 v[20:21], v92 offset:17920
    ds_read_b64_tr_b16 v[22:23], v92 offset:18048
    s_mov_b64 exec, s[54:55]
    ds_read_b128 v[20:23], v93 offset:16480
    s_mov_b64 exec, -1
    s_waitcnt lgkmcnt(8)
    v_mfma_f32_32x32x16_bf16 v[28:43], v[12:15], v[212:215], v[28:43]
    s_waitcnt lgkmcnt(4)
    v_mfma_f32_32x32x16_bf16 v[28:43], v[16:19], v[216:219], v[28:43]
    s_waitcnt vmcnt(3) lgkmcnt(0)
    s_barrier
    ds_read_b128 v[224:227], v88 offset:32768
    ds_read_b64_tr_b16 v[12:13], v92 offset:32768
    ds_read_b64_tr_b16 v[14:15], v92 offset:32896
    s_mov_b64 exec, s[54:55]
    ds_read_b128 v[12:15], v93 offset:32768
    s_mov_b64 exec, -1
    ds_read_b128 v[228:231], v89 offset:32768
    ds_read_b64_tr_b16 v[16:17], v92 offset:33280
    ds_read_b64_tr_b16 v[18:19], v92 offset:33408
    s_mov_b64 exec, s[54:55]
    ds_read_b128 v[16:19], v93 offset:32800
    s_mov_b64 exec, -1
    s_waitcnt lgkmcnt(8)
    v_mfma_f32_32x32x16_bf16 v[28:43], v[20:23], v[220:223], v[28:43]
    ds_read_b128 v[232:235], v90 offset:32768
    ds_read_b64_tr_b16 v[20:21], v92 offset:33792
    ds_read_b64_tr_b16 v[22:23], v92 offset:33920
    s_mov_b64 exec, s[54:55]
    ds_read_b128 v[20:23], v93 offset:32832
    s_mov_b64 exec, -1
    s_waitcnt lgkmcnt(8)
    v_mfma_f32_32x32x16_bf16 v[28:43], v[12:15], v[224:227], v[28:43]
    ds_read_b128 v[236:239], v91 offset:32768
    ds_read_b64_tr_b16 v[12:13], v92 offset:34304
    ds_read_b64_tr_b16 v[14:15], v92 offset:34432
    s_mov_b64 exec, s[54:55]
    ds_read_b128 v[12:15], v93 offset:32864
    s_mov_b64 exec, -1
    s_waitcnt lgkmcnt(8)
    v_mfma_f32_32x32x16_bf16 v[28:43], v[16:19], v[228:231], v[28:43]
    s_waitcnt lgkmcnt(4)
    v_mfma_f32_32x32x16_bf16 v[28:43], v[20:23], v[232:235], v[28:43]
    s_waitcnt vmcnt(0) lgkmcnt(0)
    s_barrier
    ds_read_b128 v[240:243], v88 offset:49152
    ds_read_b64_tr_b16 v[16:17], v92 offset:49152
    ds_read_b64_tr_b16 v[18:19], v92 offset:49280
    s_mov_b64 exec, s[54:55]
    ds_read_b128 v[16:19], v93 offset:49152
    s_mov_b64 exec, -1
    ds_read_b128 v[244:247], v89 offset:49152
    ds_read_b64_tr_b16 v[20:21], v92 offset:49664
    ds_read_b64_tr_b16 v[22:23], v92 offset:49792
    s_mov_b64 exec, s[54:55]
    ds_read_b128 v[20:23], v93 offset:49184
    s_mov_b64 exec, -1
    s_waitcnt lgkmcnt(8)
    v_mfma_f32_32x32x16_bf16 v[28:43], v[12:15], v[236:239], v[28:43]
    ds_read_b128 v[248:251], v90 offset:49152
    ds_read_b64_tr_b16 v[12:13], v92 offset:50176
    ds_read_b64_tr_b16 v[14:15], v92 offset:50304
    s_mov_b64 exec, s[54:55]
    ds_read_b128 v[12:15], v93 offset:49216
    s_mov_b64 exec, -1
    s_waitcnt lgkmcnt(8)
    v_mfma_f32_32x32x16_bf16 v[28:43], v[16:19], v[240:243], v[28:43]
    ds_read_b128 v[252:255], v91 offset:49152
    ds_read_b64_tr_b16 v[16:17], v92 offset:50688
    ds_read_b64_tr_b16 v[18:19], v92 offset:50816
    s_mov_b64 exec, s[54:55]
    ds_read_b128 v[16:19], v93 offset:49248
    s_mov_b64 exec, -1
    s_waitcnt lgkmcnt(8)
    v_mfma_f32_32x32x16_bf16 v[28:43], v[20:23], v[244:247], v[28:43]
    s_waitcnt lgkmcnt(4)
    v_mfma_f32_32x32x16_bf16 v[28:43], v[12:15], v[248:251], v[28:43]
    s_waitcnt lgkmcnt(0)
    v_mfma_f32_32x32x16_bf16 v[28:43], v[16:19], v[252:255], v[28:43]
    v_and_b32 v108, 0x33, v1
    v_bfe_u32 v109, v1, 2, 1
    v_lshl_or_b32 v108, v109, 3, v108
    v_bfe_u32 v109, v1, 3, 1
    v_lshl_or_b32 v108, v109, 2, v108
    v_lshlrev_b32 v108, 4, v108
    v_and_b32 v111, 32, v1
    v_lshl_add_u32 v112, v111, 3, v10
    v_cmp_gt_u32 vcc, 32, v1
    s_lshr_b32 s8, s59, 2
    s_add_u32 s8, s8, 131072
    s_nop 1
    v_mul_f32 v28, 0x3eb8aa3b, v28
    v_mul_f32 v29, 0x3eb8aa3b, v29
    v_mul_f32 v30, 0x3eb8aa3b, v30
    v_mul_f32 v31, 0x3eb8aa3b, v31
    v_mul_f32 v32, 0x3eb8aa3b, v32
    v_mul_f32 v33, 0x3eb8aa3b, v33
    v_mul_f32 v34, 0x3eb8aa3b, v34
    v_mul_f32 v35, 0x3eb8aa3b, v35
    v_cvt_pk_bf16_f32 v104, v28, v29
    v_cvt_pk_bf16_f32 v105, v30, v31
    v_cvt_pk_bf16_f32 v106, v32, v33
    v_cvt_pk_bf16_f32 v107, v34, v35
    v_mul_f32 v110, s52, v36
    buffer_store_dwordx4 v[104:107], v108, s[28:31], s59 offen sc1
    v_exp_f32 v111, -v110
    v_exp_f32 v110, v110
    v_add_f32 v111, 1.0, v111
    v_add_f32 v110, 1.0, v110
    v_rcp_f32 v110, v110
    v_min_f32 v111, 0x7f7fffff, v111
    v_cndmask_b32 v110, v110, v111, vcc
    v_mov_b32 v111, v110
    buffer_store_dwordx2 v[110:111], v112, s[28:31], s8 offen sc1
    s_waitcnt vmcnt(0)
    s_barrier
    s_cmp_eq_u32 s3, 0
    s_cbranch_scc0 Lkvs_15
    s_lshl_b32 s8, s4, 4
    s_mov_b64 exec, 1
    buffer_store_dword v8, v2, s[44:47], s8 offen sc1
    s_mov_b64 exec, -1
Lkvs_15:
    s_lshl_b32 s9, s3, 12
    s_add_u32 m0, s9, 131072
    s_mov_b32 s8, 0
    buffer_load_dwordx4 v99, s[24:27], s8 offen lds
    s_lshl_b32 s9, s3, 12
    s_add_u32 m0, s9, 132096
    s_mov_b32 s8, 16384
    buffer_load_dwordx4 v99, s[24:27], s8 offen lds
    s_lshl_b32 s9, s3, 12
    s_add_u32 m0, s9, 133120
    s_mov_b32 s8, 32768
    buffer_load_dwordx4 v99, s[24:27], s8 offen lds
    s_lshl_b32 s9, s3, 12
    s_add_u32 m0, s9, 134144
    s_mov_b32 s8, 49152
    buffer_load_dwordx4 v99, s[24:27], s8 offen lds
    v_mov_b32 v108, -1
    v_mov_b32 v109, -1
    v_mov_b32 v110, -1
    v_mov_b32 v111, -1
    buffer_store_dwordx4 v[108:111], v2, s[28:31], s60 offen sc1
    s_waitcnt vmcnt(1)
    s_barrier
    s_waitcnt lgkmcnt(0)
    s_barrier
    s_branch LA_kvjoin
LA_v:
    ds_read_b128 v[128:131], v88 offset:0
    ds_read_b64_tr_b16 v[12:13], v92 offset:0
    ds_read_b64_tr_b16 v[14:15], v92 offset:128
    ds_read_b128 v[132:135], v89 offset:0
    ds_read_b64_tr_b16 v[16:17], v92 offset:512
    ds_read_b64_tr_b16 v[18:19], v92 offset:640
    ds_read_b128 v[136:139], v90 offset:0
    ds_read_b64_tr_b16 v[20:21], v92 offset:1024
    ds_read_b64_tr_b16 v[22:23], v92 offset:1152
    s_waitcnt lgkmcnt(6)
    v_mfma_f32_32x32x16_bf16 v[28:43], v[128:131], v[12:15], 0
    ds_read_b128 v[140:143], v91 offset:0
    ds_read_b64_tr_b16 v[12:13], v92 offset:1536
    ds_read_b64_tr_b16 v[14:15], v92 offset:1664
    s_waitcnt lgkmcnt(6)
    v_mfma_f32_32x32x16_bf16 v[28:43], v[132:135], v[16:19], v[28:43]
    s_waitcnt lgkmcnt(3)
    v_mfma_f32_32x32x16_bf16 v[28:43], v[136:139], v[20:23], v[28:43]
    s_waitcnt vmcnt(6) lgkmcnt(0)
    s_barrier
    ds_read_b128 v[144:147], v88 offset:16384
    ds_read_b64_tr_b16 v[16:17], v92 offset:16384
    ds_read_b64_tr_b16 v[18:19], v92 offset:16512
    s_bfe_u32 s70, s62, 0x30010
    s_add_u32 m0, s63, 0
    s_lshl_b32 s69, s70, 7
    buffer_load_dwordx4 v96, s[12:15], s69 offen lds
    ds_read_b128 v[148:151], v89 offset:16384
    ds_read_b64_tr_b16 v[20:21], v92 offset:16896
    ds_read_b64_tr_b16 v[22:23], v92 offset:17024
    s_waitcnt lgkmcnt(6)
    v_mfma_f32_32x32x16_bf16 v[28:43], v[140:143], v[12:15], v[28:43]
    s_add_u32 m0, s64, 0
    s_lshl_b32 s70, s70, s71
    buffer_load_dwordx4 v98, s[16:19], s70 offen lds
    ds_read_b128 v[152:155], v90 offset:16384
    ds_read_b64_tr_b16 v[12:13], v92 offset:17408
    ds_read_b64_tr_b16 v[14:15], v92 offset:17536
    s_waitcnt lgkmcnt(6)
    v_mfma_f32_32x32x16_bf16 v[28:43], v[144:147], v[16:19], v[28:43]
    s_add_u32 m0, s63, 1024
    s_nop 0
    buffer_load_dwordx4 v97, s[12:15], s69 offen lds
    ds_read_b128 v[156:159], v91 offset:16384
    ds_read_b64_tr_b16 v[16:17], v92 offset:17920
    ds_read_b64_tr_b16 v[18:19], v92 offset:18048
    s_waitcnt lgkmcnt(6)
    v_mfma_f32_32x32x16_bf16 v[28:43], v[148:151], v[20:23], v[28:43]
    s_waitcnt lgkmcnt(3)
    v_mfma_f32_32x32x16_bf16 v[28:43], v[152:155], v[12:15], v[28:43]
    s_waitcnt vmcnt(6) lgkmcnt(0)
    s_barrier
    ds_read_b128 v[160:163], v88 offset:32768
    ds_read_b64_tr_b16 v[20:21], v92 offset:32768
    ds_read_b64_tr_b16 v[22:23], v92 offset:32896
    s_bfe_u32 s70, s62, 0x30014
    s_add_u32 m0, s63, 16384
    s_lshl_b32 s69, s70, 7
    buffer_load_dwordx4 v96, s[12:15], s69 offen lds
    ds_read_b128 v[164:167], v89 offset:32768
    ds_read_b64_tr_b16 v[12:13], v92 offset:33280
    ds_read_b64_tr_b16 v[14:15], v92 offset:33408
    s_waitcnt lgkmcnt(6)
    v_mfma_f32_32x32x16_bf16 v[28:43], v[156:159], v[16:19], v[28:43]
    s_add_u32 m0, s64, 16384
    s_lshl_b32 s70, s70, s71
    buffer_load_dwordx4 v98, s[16:19], s70 offen lds
    ds_read_b128 v[168:171], v90 offset:32768
    ds_read_b64_tr_b16 v[16:17], v92 offset:33792
    ds_read_b64_tr_b16 v[18:19], v92 offset:33920
    s_waitcnt lgkmcnt(6)
    v_mfma_f32_32x32x16_bf16 v[28:43], v[160:163], v[20:23], v[28:43]
    s_add_u32 m0, s63, 17408
    s_nop 0
    buffer_load_dwordx4 v97, s[12:15], s69 offen lds
    ds_read_b128 v[172:175], v91 offset:32768
    ds_read_b64_tr_b16 v[20:21], v92 offset:34304
    ds_read_b64_tr_b16 v[22:23], v92 offset:34432
    s_waitcnt lgkmcnt(6)
    v_mfma_f32_32x32x16_bf16 v[28:43], v[164:167], v[12:15], v[28:43]
    s_waitcnt lgkmcnt(3)
    v_mfma_f32_32x32x16_bf16 v[28:43], v[168:171], v[16:19], v[28:43]
    s_waitcnt vmcnt(6) lgkmcnt(0)
    s_barrier
    ds_read_b128 v[176:179], v88 offset:49152
    ds_read_b64_tr_b16 v[12:13], v92 offset:49152
    ds_read_b64_tr_b16 v[14:15], v92 offset:49280
    s_bfe_u32 s70, s62, 0x30018
    s_add_u32 m0, s63, 32768
    s_lshl_b32 s69, s70, 7
    buffer_load_dwordx4 v96, s[12:15], s69 offen lds
    ds_read_b128 v[180:183], v89 offset:49152
    ds_read_b64_tr_b16 v[16:17], v92 offset:49664
    ds_read_b64_tr_b16 v[18:19], v92 offset:49792
    s_waitcnt lgkmcnt(6)
    v_mfma_f32_32x32x16_bf16 v[28:43], v[172:175], v[20:23], v[28:43]
    s_add_u32 m0, s64, 32768
    s_lshl_b32 s70, s70, s71
    buffer_load_dwordx4 v98, s[16:19], s70 offen lds
    ds_read_b128 v[184:187], v90 offset:49152
    ds_read_b64_tr_b16 v[20:21], v92 offset:50176
    ds_read_b64_tr_b16 v[22:23], v92 offset:50304
    s_waitcnt lgkmcnt(6)
    v_mfma_f32_32x32x16_bf16 v[28:43], v[176:179], v[12:15], v[28:43]
    s_add_u32 m0, s63, 33792
    s_nop 0
    buffer_load_dwordx4 v97, s[12:15], s69 offen lds
    ds_read_b128 v[188:191], v91 offset:49152
    ds_read_b64_tr_b16 v[12:13], v92 offset:50688
    ds_read_b64_tr_b16 v[14:15], v92 offset:50816
    s_waitcnt lgkmcnt(6)
    v_mfma_f32_32x32x16_bf16 v[28:43], v[180:183], v[16:19], v[28:43]
    s_waitcnt lgkmcnt(3)
    v_mfma_f32_32x32x16_bf16 v[28:43], v[184:187], v[20:23], v[28:43]
    s_waitcnt vmcnt(6) lgkmcnt(0)
    s_barrier
    ds_read_b128 v[192:195], v88 offset:0
    ds_read_b64_tr_b16 v[16:17], v92 offset:0
    ds_read_b64_tr_b16 v[18:19], v92 offset:128
    s_bfe_u32 s70, s62, 0x3001c
    s_add_u32 m0, s63, 49152
    s_lshl_b32 s69, s70, 7
    buffer_load_dwordx4 v96, s[12:15], s69 offen lds
    ds_read_b128 v[196:199], v89 offset:0
    ds_read_b64_tr_b16 v[20:21], v92 offset:512
    ds_read_b64_tr_b16 v[22:23], v92 offset:640
    s_waitcnt lgkmcnt(6)
    v_mfma_f32_32x32x16_bf16 v[28:43], v[188:191], v[12:15], v[28:43]
    s_add_u32 m0, s64, 49152
    s_lshl_b32 s70, s70, s71
    buffer_load_dwordx4 v98, s[16:19], s70 offen lds
    ds_read_b128 v[200:203], v90 offset:0
    ds_read_b64_tr_b16 v[12:13], v92 offset:1024
    ds_read_b64_tr_b16 v[14:15], v92 offset:1152
    s_waitcnt lgkmcnt(6)
    v_mfma_f32_32x32x16_bf16 v[28:43], v[192:195], v[16:19], v[28:43]
    s_add_u32 m0, s63, 50176
    s_nop 0
    buffer_load_dwordx4 v97, s[12:15], s69 offen lds
    ds_read_b128 v[204:207], v91 offset:0
    ds_read_b64_tr_b16 v[16:17], v92 offset:1536
    ds_read_b64_tr_b16 v[18:19], v92 offset:1664
    s_waitcnt lgkmcnt(6)
    v_mfma_f32_32x32x16_bf16 v[28:43], v[196:199], v[20:23], v[28:43]
    s_waitcnt lgkmcnt(3)
    v_mfma_f32_32x32x16_bf16 v[28:43], v[200:203], v[12:15], v[28:43]
    s_waitcnt vmcnt(6) lgkmcnt(0)
    s_barrier
    ds_read_b128 v[208:211], v88 offset:16384
    ds_read_b64_tr_b16 v[20:21], v92 offset:16384
    ds_read_b64_tr_b16 v[22:23], v92 offset:16512
    ds_read_b128 v[212:215], v89 offset:16384
    ds_read_b64_tr_b16 v[12:13], v92 offset:16896
    ds_read_b64_tr_b16 v[14:15], v92 offset:17024
    s_waitcnt lgkmcnt(6)
    v_mfma_f32_32x32x16_bf16 v[28:43], v[204:207], v[16:19], v[28:43]
    ds_read_b128 v[216:219], v90 offset:16384
    ds_read_b64_tr_b16 v[16:17], v92 offset:17408
    ds_read_b64_tr_b16 v[18:19], v92 offset:17536
    s_waitcnt lgkmcnt(6)
    v_mfma_f32_32x32x16_bf16 v[28:43], v[208:211], v[20:23], v[28:43]
    ds_read_b128 v[220:223], v91 offset:16384
    ds_read_b64_tr_b16 v[20:21], v92 offset:17920
    ds_read_b64_tr_b16 v[22:23], v92 offset:18048
    s_waitcnt lgkmcnt(6)
    v_mfma_f32_32x32x16_bf16 v[28:43], v[212:215], v[12:15], v[28:43]
    s_waitcnt lgkmcnt(3)
    v_mfma_f32_32x32x16_bf16 v[28:43], v[216:219], v[16:19], v[28:43]
    s_waitcnt vmcnt(3) lgkmcnt(0)
    s_barrier
    ds_read_b128 v[224:227], v88 offset:32768
    ds_read_b64_tr_b16 v[12:13], v92 offset:32768
    ds_read_b64_tr_b16 v[14:15], v92 offset:32896
    ds_read_b128 v[228:231], v89 offset:32768
    ds_read_b64_tr_b16 v[16:17], v92 offset:33280
    ds_read_b64_tr_b16 v[18:19], v92 offset:33408
    s_waitcnt lgkmcnt(6)
    v_mfma_f32_32x32x16_bf16 v[28:43], v[220:223], v[20:23], v[28:43]
    ds_read_b128 v[232:235], v90 offset:32768
    ds_read_b64_tr_b16 v[20:21], v92 offset:33792
    ds_read_b64_tr_b16 v[22:23], v92 offset:33920
    s_waitcnt lgkmcnt(6)
    v_mfma_f32_32x32x16_bf16 v[28:43], v[224:227], v[12:15], v[28:43]
    ds_read_b128 v[236:239], v91 offset:32768
    ds_read_b64_tr_b16 v[12:13], v92 offset:34304
    ds_read_b64_tr_b16 v[14:15], v92 offset:34432
    s_waitcnt lgkmcnt(6)
    v_mfma_f32_32x32x16_bf16 v[28:43], v[228:231], v[16:19], v[28:43]
    s_waitcnt lgkmcnt(3)
    v_mfma_f32_32x32x16_bf16 v[28:43], v[232:235], v[20:23], v[28:43]
    s_waitcnt vmcnt(0) lgkmcnt(0)
    s_barrier
    ds_read_b128 v[240:243], v88 offset:49152
    ds_read_b64_tr_b16 v[16:17], v92 offset:49152
    ds_read_b64_tr_b16 v[18:19], v92 offset:49280
    ds_read_b128 v[244:247], v89 offset:49152
    ds_read_b64_tr_b16 v[20:21], v92 offset:49664
    ds_read_b64_tr_b16 v[22:23], v92 offset:49792
    s_waitcnt lgkmcnt(6)
    v_mfma_f32_32x32x16_bf16 v[28:43], v[236:239], v[12:15], v[28:43]
    ds_read_b128 v[248:251], v90 offset:49152
    ds_read_b64_tr_b16 v[12:13], v92 offset:50176
    ds_read_b64_tr_b16 v[14:15], v92 offset:50304
    s_waitcnt lgkmcnt(6)
    v_mfma_f32_32x32x16_bf16 v[28:43], v[240:243], v[16:19], v[28:43]
    ds_read_b128 v[252:255], v91 offset:49152
    ds_read_b64_tr_b16 v[16:17], v92 offset:50688
    ds_read_b64_tr_b16 v[18:19], v92 offset:50816
    s_waitcnt lgkmcnt(6)
    v_mfma_f32_32x32x16_bf16 v[28:43], v[244:247], v[20:23], v[28:43]
    s_waitcnt lgkmcnt(3)
    v_mfma_f32_32x32x16_bf16 v[28:43], v[248:251], v[12:15], v[28:43]
    s_waitcnt lgkmcnt(0)
    v_mfma_f32_32x32x16_bf16 v[28:43], v[252:255], v[16:19], v[28:43]
    v_and_b32 v112, 15, v1
    v_bfe_u32 v113, v1, 4, 1
    v_lshl_or_b32 v112, v113, 5, v112
    v_bfe_u32 v113, v1, 5, 1
    v_lshl_or_b32 v112, v113, 4, v112
    v_lshlrev_b32 v112, 4, v112
    s_nop 5
    v_cvt_pk_bf16_f32 v104, v28, v29
    v_cvt_pk_bf16_f32 v105, v30, v31
    v_cvt_pk_bf16_f32 v106, v32, v33
    v_cvt_pk_bf16_f32 v107, v34, v35
    v_cvt_pk_bf16_f32 v108, v36, v37
    v_cvt_pk_bf16_f32 v109, v38, v39
    v_cvt_pk_bf16_f32 v110, v40, v41
    v_cvt_pk_bf16_f32 v111, v42, v43
    v_cndmask_b32 v104, v104, v108, s[54:55]
    v_cndmask_b32 v105, v105, v109, s[54:55]
    v_cndmask_b32 v106, v106, v110, s[54:55]
    v_cndmask_b32 v107, v107, v111, s[54:55]
    buffer_store_dwordx4 v[104:107], v112, s[28:31], s59 offen offset:1024 sc1
    s_lshl_b32 s8, s4, 7
    s_add_u32 s8, s8, 163840
    buffer_store_dword v44, v120, s[28:31], s8 offen sc1
    s_waitcnt vmcnt(0)
    s_barrier
    s_lshl_b32 s9, s3, 12
    s_add_u32 m0, s9, 131072
    s_mov_b32 s8, 0
    buffer_load_dwordx4 v99, s[24:27], s8 offen lds
    s_lshl_b32 s9, s3, 12
    s_add_u32 m0, s9, 132096
    s_mov_b32 s8, 16384
    buffer_load_dwordx4 v99, s[24:27], s8 offen lds
    s_lshl_b32 s9, s3, 12
    s_add_u32 m0, s9, 133120
    s_mov_b32 s8, 32768
    buffer_load_dwordx4 v99, s[24:27], s8 offen lds
    s_lshl_b32 s9, s3, 12
    s_add_u32 m0, s9, 134144
    s_mov_b32 s8, 49152
    buffer_load_dwordx4 v99, s[24:27], s8 offen lds
    v_mov_b32 v108, -1
    v_mov_b32 v109, -1
    v_mov_b32 v110, -1
    v_mov_b32 v111, -1
    buffer_store_dwordx4 v[108:111], v2, s[28:31], s60 offen sc1
    s_waitcnt vmcnt(1)
    s_barrier
    ds_read_b64_tr_b16 v[20:21], v94 offset:0
    ds_read_b64_tr_b16 v[22:23], v94 offset:256
    ds_read_b64_tr_b16 v[12:13], v94 offset:1024
    ds_read_b64_tr_b16 v[14:15], v94 offset:1280
    ds_read_b64_tr_b16 v[16:17], v94 offset:2048
    ds_read_b64_tr_b16 v[18:19], v94 offset:2304
    s_waitcnt lgkmcnt(4)
    v_mfma_f32_32x32x16_bf16 v[28:43], v[20:23], v[128:131], 0
    ds_read_b64_tr_b16 v[20:21], v94 offset:3072
    ds_read_b64_tr_b16 v[22:23], v94 offset:3328
    s_waitcnt lgkmcnt(4)
    v_mfma_f32_32x32x16_bf16 v[28:43], v[12:15], v[132:135], v[28:43]
    ds_read_b64_tr_b16 v[12:13], v94 offset:4096
    ds_read_b64_tr_b16 v[14:15], v94 offset:4352
    s_waitcnt lgkmcnt(4)
    v_mfma_f32_32x32x16_bf16 v[28:43], v[16:19], v[136:139], v[28:43]
    ds_read_b64_tr_b16 v[16:17], v94 offset:5120
    ds_read_b64_tr_b16 v[18:19], v94 offset:5376
    s_waitcnt lgkmcnt(4)
    v_mfma_f32_32x32x16_bf16 v[28:43], v[20:23], v[140:143], v[28:43]
    ds_read_b64_tr_b16 v[20:21], v94 offset:6144
    ds_read_b64_tr_b16 v[22:23], v94 offset:6400
    s_waitcnt lgkmcnt(4)
    v_mfma_f32_32x32x16_bf16 v[28:43], v[12:15], v[144:147], v[28:43]
    ds_read_b64_tr_b16 v[12:13], v94 offset:7168
    ds_read_b64_tr_b16 v[14:15], v94 offset:7424
    s_waitcnt lgkmcnt(4)
    v_mfma_f32_32x32x16_bf16 v[28:43], v[16:19], v[148:151], v[28:43]
    ds_read_b64_tr_b16 v[16:17], v94 offset:8192
    ds_read_b64_tr_b16 v[18:19], v94 offset:8448
    s_waitcnt lgkmcnt(4)
    v_mfma_f32_32x32x16_bf16 v[28:43], v[20:23], v[152:155], v[28:43]
    ds_read_b64_tr_b16 v[20:21], v94 offset:9216
    ds_read_b64_tr_b16 v[22:23], v94 offset:9472
    s_waitcnt lgkmcnt(4)
    v_mfma_f32_32x32x16_bf16 v[28:43], v[12:15], v[156:159], v[28:43]
    ds_read_b64_tr_b16 v[12:13], v94 offset:10240
    ds_read_b64_tr_b16 v[14:15], v94 offset:10496
    s_waitcnt lgkmcnt(4)
    v_mfma_f32_32x32x16_bf16 v[28:43], v[16:19], v[160:163], v[28:43]
    ds_read_b64_tr_b16 v[16:17], v94 offset:11264
    ds_read_b64_tr_b16 v[18:19], v94 offset:11520
    s_waitcnt lgkmcnt(4)
    v_mfma_f32_32x32x16_bf16 v[28:43], v[20:23], v[164:167], v[28:43]
    ds_read_b64_tr_b16 v[20:21], v94 offset:12288
    ds_read_b64_tr_b16 v[22:23], v94 offset:12544
    s_waitcnt lgkmcnt(4)
    v_mfma_f32_32x32x16_bf16 v[28:43], v[12:15], v[168:171], v[28:43]
    ds_read_b64_tr_b16 v[12:13], v94 offset:13312
    ds_read_b64_tr_b16 v[14:15], v94 offset:13568
    s_waitcnt lgkmcnt(4)
    v_mfma_f32_32x32x16_bf16 v[28:43], v[16:19], v[172:175], v[28:43]
    ds_read_b64_tr_b16 v[16:17], v94 offset:14336
    ds_read_b64_tr_b16 v[18:19], v94 offset:14592
    s_waitcnt lgkmcnt(4)
    v_mfma_f32_32x32x16_bf16 v[28:43], v[20:23], v[176:179], v[28:43]
    ds_read_b64_tr_b16 v[20:21], v94 offset:15360
    ds_read_b64_tr_b16 v[22:23], v94 offset:15616
    s_waitcnt lgkmcnt(4)
    v_mfma_f32_32x32x16_bf16 v[28:43], v[12:15], v[180:183], v[28:43]
    ds_read_b64_tr_b16 v[12:13], v94 offset:16384
    ds_read_b64_tr_b16 v[14:15], v94 offset:16640
    s_waitcnt lgkmcnt(4)
    v_mfma_f32_32x32x16_bf16 v[28:43], v[16:19], v[184:187], v[28:43]
    ds_read_b64_tr_b16 v[16:17], v94 offset:17408
    ds_read_b64_tr_b16 v[18:19], v94 offset:17664
    s_waitcnt lgkmcnt(4)
    v_mfma_f32_32x32x16_bf16 v[28:43], v[20:23], v[188:191], v[28:43]
    ds_read_b64_tr_b16 v[20:21], v94 offset:18432
    ds_read_b64_tr_b16 v[22:23], v94 offset:18688
    s_waitcnt lgkmcnt(4)
    v_mfma_f32_32x32x16_bf16 v[28:43], v[12:15], v[192:195], v[28:43]
    ds_read_b64_tr_b16 v[12:13], v94 offset:19456
    ds_read_b64_tr_b16 v[14:15], v94 offset:19712
    s_waitcnt lgkmcnt(4)
    v_mfma_f32_32x32x16_bf16 v[28:43], v[16:19], v[196:199], v[28:43]
    ds_read_b64_tr_b16 v[16:17], v94 offset:20480
    ds_read_b64_tr_b16 v[18:19], v94 offset:20736
    s_waitcnt lgkmcnt(4)
    v_mfma_f32_32x32x16_bf16 v[28:43], v[20:23], v[200:203], v[28:43]
    ds_read_b64_tr_b16 v[20:21], v94 offset:21504
    ds_read_b64_tr_b16 v[22:23], v94 offset:21760
    s_waitcnt lgkmcnt(4)
    v_mfma_f32_32x32x16_bf16 v[28:43], v[12:15], v[204:207], v[28:43]
    ds_read_b64_tr_b16 v[12:13], v94 offset:22528
    ds_read_b64_tr_b16 v[14:15], v94 offset:22784
    s_waitcnt lgkmcnt(4)
    v_mfma_f32_32x32x16_bf16 v[28:43], v[16:19], v[208:211], v[28:43]
    ds_read_b64_tr_b16 v[16:17], v94 offset:23552
    ds_read_b64_tr_b16 v[18:19], v94 offset:23808
    s_waitcnt lgkmcnt(4)
    v_mfma_f32_32x32x16_bf16 v[28:43], v[20:23], v[212:215], v[28:43]
    ds_read_b64_tr_b16 v[20:21], v94 offset:24576
    ds_read_b64_tr_b16 v[22:23], v94 offset:24832
    s_waitcnt lgkmcnt(4)
    v_mfma_f32_32x32x16_bf16 v[28:43], v[12:15], v[216:219], v[28:43]
    ds_read_b64_tr_b16 v[12:13], v94 offset:25600
    ds_read_b64_tr_b16 v[14:15], v94 offset:25856
    s_waitcnt lgkmcnt(4)
    v_mfma_f32_32x32x16_bf16 v[28:43], v[16:19], v[220:223], v[28:43]
    ds_read_b64_tr_b16 v[16:17], v94 offset:26624
    ds_read_b64_tr_b16 v[18:19], v94 offset:26880
    s_waitcnt lgkmcnt(4)
    v_mfma_f32_32x32x16_bf16 v[28:43], v[20:23], v[224:227], v[28:43]
    ds_read_b64_tr_b16 v[20:21], v94 offset:27648
    ds_read_b64_tr_b16 v[22:23], v94 offset:27904
    s_waitcnt lgkmcnt(4)
    v_mfma_f32_32x32x16_bf16 v[28:43], v[12:15], v[228:231], v[28:43]
    ds_read_b64_tr_b16 v[12:13], v94 offset:28672
    ds_read_b64_tr_b16 v[14:15], v94 offset:28928
    s_waitcnt lgkmcnt(4)
    v_mfma_f32_32x32x16_bf16 v[28:43], v[16:19], v[232:235], v[28:43]
    ds_read_b64_tr_b16 v[16:17], v94 offset:29696
    ds_read_b64_tr_b16 v[18:19], v94 offset:29952
    s_waitcnt lgkmcnt(4)
    v_mfma_f32_32x32x16_bf16 v[28:43], v[20:23], v[236:239], v[28:43]
    ds_read_b64_tr_b16 v[20:21], v94 offset:30720
    ds_read_b64_tr_b16 v[22:23], v94 offset:30976
    s_waitcnt lgkmcnt(4)
    v_mfma_f32_32x32x16_bf16 v[28:43], v[12:15], v[240:243], v[28:43]
    ds_read_b64_tr_b16 v[12:13], v94 offset:31744
    ds_read_b64_tr_b16 v[14:15], v94 offset:32000
    s_waitcnt lgkmcnt(4)
    v_mfma_f32_32x32x16_bf16 v[28:43], v[16:19], v[244:247], v[28:43]
    s_waitcnt lgkmcnt(2)
    v_mfma_f32_32x32x16_bf16 v[28:43], v[20:23], v[248:251], v[28:43]
    s_waitcnt lgkmcnt(0)
    v_mfma_f32_32x32x16_bf16 v[28:43], v[12:15], v[252:255], v[28:43]
    buffer_load_dword v121, v0, s[44:47], s21 offen sc1
    s_nop 9
    s_nop 1
    v_cvt_pk_bf16_f32 v28, v28, v29
    v_cvt_pk_bf16_f32 v29, v30, v31
    v_cvt_pk_bf16_f32 v30, v32, v33
    v_cvt_pk_bf16_f32 v31, v34, v35
    v_cvt_pk_bf16_f32 v32, v36, v37
    v_cvt_pk_bf16_f32 v33, v38, v39
    v_cvt_pk_bf16_f32 v34, v40, v41
    v_cvt_pk_bf16_f32 v35, v42, v43
    ds_write_b128 v123, v[28:31]
    ds_write_b128 v123, v[32:35] offset:4096
    s_waitcnt vmcnt(0)
    v_cmp_ne_u32 vcc, v8, v121
    s_and_b32 s8, vcc_lo, s20
    s_cbranch_scc1 Lpoll_16
Lpok_17:
    s_waitcnt lgkmcnt(0)
    s_barrier
LA_kvjoin:
    s_add_u32 s8, s73, 98304
    s_add_u32 m0, s58, 98304
    s_and_b32 s8, s8, 0x1ffff
    buffer_load_dwordx4 v2, s[28:31], s8 offen sc1 lds
    s_add_u32 s8, s73, 106496
    s_add_u32 m0, s58, 106496
    s_and_b32 s8, s8, 0x1ffff
    buffer_load_dwordx4 v2, s[28:31], s8 offen sc1 lds
    s_add_u32 s8, s73, 114688
    s_add_u32 m0, s58, 114688
    s_and_b32 s8, s8, 0x1ffff
    buffer_load_dwordx4 v2, s[28:31], s8 offen sc1 lds
    s_add_u32 s8, s73, 122880
    s_add_u32 m0, s58, 122880
    s_and_b32 s8, s8, 0x1ffff
    buffer_load_dwordx4 v2, s[28:31], s8 offen sc1 lds
    s_add_u32 s8, s73, 0
    s_add_u32 m0, s58, 0
    s_and_b32 s8, s8, 0x1ffff
    buffer_load_dwordx4 v2, s[28:31], s8 offen sc1 lds
    s_add_u32 s8, s73, 8192
    s_add_u32 m0, s58, 8192
    s_and_b32 s8, s8, 0x1ffff
    buffer_load_dwordx4 v2, s[28:31], s8 offen sc1 lds
    s_add_u32 s8, s73, 16384
    s_add_u32 m0, s58, 16384
    s_and_b32 s8, s8, 0x1ffff
    buffer_load_dwordx4 v2, s[28:31], s8 offen sc1 lds
    s_add_u32 s8, s73, 24576
    s_add_u32 m0, s58, 24576
    s_and_b32 s8, s8, 0x1ffff
    buffer_load_dwordx4 v2, s[28:31], s8 offen sc1 lds
    s_waitcnt vmcnt(4)
    s_branch LA_join2
Lpoll_16:
    s_cmp_eq_u32 s61, 0
    s_cbranch_scc1 Lpok_17
    s_sub_u32 s61, s61, 1
    s_sleep 8
    buffer_load_dword v121, v0, s[44:47], 0 offen sc1
    s_waitcnt vmcnt(0)
    v_cmp_ne_u32 vcc, v8, v121
    s_cbranch_vccnz Lpoll_16
    s_branch Lpok_17
L_fallback:
    v_mov_b32 v64, v2
    v_mov_b32 v66, 0xff800000
    s_mov_b32 s8, 64
L_fb1:
    ds_read_b128 v[60:63], v64
    v_add_u32 v64, 0x800, v64
    s_waitcnt lgkmcnt(0)
    v_mfma_f32_32x32x16_bf16 v[12:27], v[60:63], v[84:87], 0
    s_nop 11
    v_max3_f32 v66, v66, v12, v13
    v_max3_f32 v66, v66, v14, v15
    v_max3_f32 v66, v66, v16, v17
    v_max3_f32 v66, v66, v18, v19
    v_max3_f32 v66, v66, v20, v21
    v_max3_f32 v66, v66, v22, v23
    v_max3_f32 v66, v66, v24, v25
    v_max3_f32 v66, v66, v26, v27
    s_sub_u32 s8, s8, 1
    s_cmp_lg_u32 s8, 0
    s_cbranch_scc1 L_fb1
    v_mov_b32 v67, v66
    s_nop 1
    v_permlane32_swap_b32 v67, v66
    s_nop 1
    v_max_f32 v66, v66, v67
    v_sub_f32 v28, 0, v66
    v_sub_f32 v29, 0, v66
    v_sub_f32 v30, 0, v66
    v_sub_f32 v31, 0, v66
    v_sub_f32 v32, 0, v66
    v_sub_f32 v33, 0, v66
    v_sub_f32 v34, 0, v66
    v_sub_f32 v35, 0, v66
    v_sub_f32 v36, 0, v66
    v_sub_f32 v37, 0, v66
    v_sub_f32 v38, 0, v66
    v_sub_f32 v39, 0, v66
    v_sub_f32 v40, 0, v66
    v_sub_f32 v41, 0, v66
    v_sub_f32 v42, 0, v66
    v_sub_f32 v43, 0, v66
    v_mov_b32 v44, 0
    v_mov_b32 v45, 0
    v_mov_b32 v46, 0
    v_mov_b32 v47, 0
    v_mov_b32 v48, 0
    v_mov_b32 v49, 0
    v_mov_b32 v50, 0
    v_mov_b32 v51, 0
    v_mov_b32 v52, 0
    v_mov_b32 v53, 0
    v_mov_b32 v54, 0
    v_mov_b32 v55, 0
    v_mov_b32 v56, 0
    v_mov_b32 v57, 0
    v_mov_b32 v58, 0
    v_mov_b32 v59, 0
    v_mov_b32 v64, v2
    v_mov_b32 v65, v3
    s_mov_b32 s8, 64
L_fb2:
    ds_read_b128 v[60:63], v64
    s_mov_b64 exec, s[54:55]
    ds_read_b128 v[68:71], v65
    ds_read_b128 v[72:75], v65 offset:512
    s_mov_b64 exec, -1
    v_add_u32 v64, 0x800, v64
    v_add_u32 v65, 0x800, v65
    s_waitcnt lgkmcnt(0)
    v_mfma_f32_32x32x16_bf16 v[12:27], v[60:63], v[84:87], v[28:43]
    s_nop 11
    v_exp_f32 v12, v12
    v_exp_f32 v13, v13
    v_exp_f32 v14, v14
    v_exp_f32 v15, v15
    v_exp_f32 v16, v16
    v_exp_f32 v17, v17
    v_exp_f32 v18, v18
    v_exp_f32 v19, v19
    v_exp_f32 v20, v20
    v_exp_f32 v21, v21
    v_exp_f32 v22, v22
    v_exp_f32 v23, v23
    v_exp_f32 v24, v24
    v_exp_f32 v25, v25
    v_exp_f32 v26, v26
    v_exp_f32 v27, v27
    s_nop 1
    v_smfmac_f32_32x32x32_bf16 v[44:59], v[68:71], v[12:19], v8
    v_smfmac_f32_32x32x32_bf16 v[44:59], v[72:75], v[20:27], v8
    s_sub_u32 s8, s8, 1
    s_cmp_lg_u32 s8, 0
    s_cbranch_scc1 L_fb2
    s_nop 11
    s_branch L_fbdone
L_end:
    s_endpgm
.section .rodata,"a"
.p2align 6
.amdhsa_kernel gated_mix__grouped_kv_mqa__glu_gated_swiglu__prompt_kernel
  .amdhsa_next_free_vgpr 256
  .amdhsa_next_free_sgpr 102
  .amdhsa_accum_offset 256
  .amdhsa_group_segment_fixed_size 0
  .amdhsa_kernarg_size 104
  .amdhsa_user_sgpr_count 2
  .amdhsa_user_sgpr_kernarg_segment_ptr 1
  .amdhsa_system_sgpr_workgroup_id_x 1
.end_amdhsa_kernel
```
